```python
import torch

def _softmax(x, axis=-1):
    return torch.softmax(x, dim=axis)
def _gelu(x):
    return torch.nn.functional.gelu(x, approximate="tanh")
def _silu(x):
    return torch.nn.functional.silu(x)
def _sigmoid(x):
    return torch.sigmoid(x)
def _layernorm(x, axis=-1, eps=1e-5):
    m = x.mean(dim=axis, keepdim=True)
    v = x.var(dim=axis, keepdim=True, unbiased=False)
    return (x - m) / torch.sqrt(v + eps)
def _scatter_add(tgt, idx, src, axis=0):
    return tgt.clone().index_add_(axis, idx, src)
def _segment_sum(src, seg, n):
    out = torch.zeros((n,) + src.shape[1:], dtype=src.dtype)
    return out.index_add_(0, seg, src)
def _pad(x, pw):
    flat = tuple(v for pair in reversed(pw) for v in pair)
    return torch.nn.functional.pad(x, flat)

kernel_name = 'gated_mix__ssm_conv_s4__spectral_gfnet__prompt'

def setup_inputs():

    _w = (lambda a: (lambda t: t.to(torch.bfloat16) if t.is_floating_point() else t)(torch.as_tensor(a)))
    def _A_setup():
        B, L, D, N = 1, 2048, 448, 256
        A_re = -(lambda _x: torch.exp(torch.as_tensor(_x)))((lambda *s: torch.randn(*s, dtype=torch.bfloat16) * 3.2)(D, N))
        A_im = torch.pi * (lambda *s: torch.randn(*s, dtype=torch.bfloat16) * 0.05)(D, N)
        B_re = (lambda *s: torch.randn(*s, dtype=torch.bfloat16) * 0.1)(D, N)
        B_im = (lambda *s: torch.randn(*s, dtype=torch.bfloat16) * 0.1)(D, N)
        C_re = (lambda *s: torch.randn(*s, dtype=torch.bfloat16) * 0.1)(D, N)
        C_im = (lambda *s: torch.randn(*s, dtype=torch.bfloat16) * 0.1)(D, N)
        log_dt = (lambda *s: torch.randn(*s, dtype=torch.bfloat16) * 0.05)(D) * 0.5 - 4.0
        Dskip = (lambda *s: torch.randn(*s, dtype=torch.bfloat16) * 0.05)(D)
        return {
            "u": _w((lambda *s: torch.randn(*s, dtype=torch.bfloat16) * 0.05)(B, L, D)),
            "A_re": _w(A_re),
            "A_im": _w(A_im),
            "B_re": _w(B_re),
            "B_im": _w(B_im),
            "C_re": _w(C_re),
            "C_im": _w(C_im),
            "log_dt": _w(log_dt),
            "Dskip": _w(Dskip),
        }
    _A_in = _A_setup()

    def _B_setup():
        B, S, D = 1, 2048, 448
        Df = D // 2 + 1
        return {
            "x": _w((lambda *s: torch.randn(*s, dtype=torch.bfloat16) * 0.05)(B, S, D)),
            "w_r": _w((lambda *s: torch.randn(*s, dtype=torch.bfloat16) * 1.6)(S, Df) * 0.02),
            "w_i": _w((lambda *s: torch.randn(*s, dtype=torch.bfloat16) * 1.6)(S, Df) * 0.02),
        }
    _B_in = _B_setup()

    return {
        "A_u": _A_in["u"],
        "A_A_re": _A_in["A_re"],
        "A_A_im": _A_in["A_im"],
        "A_B_re": _A_in["B_re"],
        "A_B_im": _A_in["B_im"],
        "A_C_re": _A_in["C_re"],
        "A_C_im": _A_in["C_im"],
        "A_log_dt": _A_in["log_dt"],
        "A_Dskip": _A_in["Dskip"],
        "B_x": _B_in["x"],
        "B_w_r": _B_in["w_r"],
        "B_w_i": _B_in["w_i"],
        "gate_w": _w((lambda *s: torch.randn(*s, dtype=torch.bfloat16) * 0.05)(448) * 16.0),
    }

def reference(A_u, A_A_re, A_A_im, A_B_re, A_B_im, A_C_re, A_C_im, A_log_dt, A_Dskip, B_x, B_w_r, B_w_i, gate_w):
    def _A_ref(u, A_re, A_im, B_re, B_im, C_re, C_im, log_dt, Dskip):
        Bsz, L, D = u.shape
        dt = torch.exp(log_dt)[:, None]
        A = A_re + 1j * A_im
        Bc = B_re + 1j * B_im
        Cc = C_re + 1j * C_im
        logdA = dt * A
        dB = dt * Bc
        l = (lambda x, dt: x.to(dt))(torch.arange(L), A_re.dtype)
        P = torch.exp(logdA[:, :, None] * l[None, None, :])
        K = torch.einsum("dn,dnl,dn->dl", Cc, P, dB).real
        L2 = 2 * L
        Kp = _pad(K, ((0, 0), (0, L)))
        up = (lambda x, *d: x.permute(*d))(u, 0, 2, 1)
        up = _pad(up, ((0, 0), (0, 0), (0, L)))
        Kf = (lambda x, axes=(-2,-1): torch.fft.rfft2(x.float(), dim=axes))(Kp[:, None, :], axes=(-2, -1))
        Uf = (lambda x, axes=(-2,-1): torch.fft.rfft2(x.float(), dim=axes))(up[:, :, None, :], axes=(-2, -1))
        Yf = Uf * Kf[None, :, :, :]
        y = (lambda x, s, axes=(-2,-1): torch.fft.irfft2(x, s=s, dim=axes).to(torch.bfloat16))(Yf, (1, L2), axes=(-2, -1))[:, :, 0, :L]
        y = (lambda x, *d: x.permute(*d))(y, 0, 2, 1) + u * Dskip[None, None, :]
        return y

    def _B_ref(x, w_r, w_i):
        B, S, D = x.shape
        X = (lambda x, axes=(-2,-1): torch.fft.rfft2(x.float(), dim=axes))(x, axes=(-2, -1))
        W = w_r + 1j * w_i
        X = X * W
        y = (lambda x, s, axes=(-2,-1): torch.fft.irfft2(x, s=s, dim=axes).to(torch.bfloat16))(X, (S, D), axes=(-2, -1))
        return y

    x = A_u
    g = _sigmoid((x * gate_w).sum(-1, keepdims=True))
    a = _A_ref(x, A_A_re, A_A_im, A_B_re, A_B_im, A_C_re, A_C_im, A_log_dt, A_Dskip)
    b = _B_ref(x, B_w_r, B_w_i)
    return g * a + (1 - g) * b
```

```asm
; @launch kernel=ssm_prep_kernel grid=(704,1,1) block=(256,1,1) lds=53504
; @launch kernel=ssm_mix_kernel grid=(449,1,1) block=(256,1,1) lds=56320
; @launch kernel=ssm_out_kernel grid=(256,1,1) block=(512,1,1) lds=83200
.amdgcn_target "amdgcn-amd-amdhsa--gfx950"
.text
.p2align 8
code_begin:
.globl ssm_prep_kernel
.p2align 8
.type ssm_prep_kernel,@function
ssm_prep_kernel:
    s_load_dwordx16 s[16:31], s[0:1], 0
    s_load_dwordx16 s[32:47], s[0:1], 64
    s_cmp_lt_u32 s2, 16
    s_cbranch_scc0 L_k1_nopf
    s_getpc_b64 s[66:67]
L_k1_pc:
    s_sub_u32 s66, s66, (L_k1_pc - code_begin)
    s_subb_u32 s67, s67, 0
    v_lshlrev_b32 v120, 6, v0
    v_min_u32 v120, (code_end - code_begin - 4), v120
    v_mov_b32 v121, s67
    v_add_co_u32 v120, vcc, s66, v120
    s_nop 1
    v_addc_co_u32 v121, vcc, 0, v121, vcc
    global_load_dword v124, v[120:121], off
    v_lshlrev_b32 v122, 6, v0
    v_add_u32 v122, 0x4000, v122
    v_min_u32 v122, (code_end - code_begin - 4), v122
    v_mov_b32 v123, s67
    v_add_co_u32 v122, vcc, s66, v122
    s_nop 1
    v_addc_co_u32 v123, vcc, 0, v123, vcc
    global_load_dword v125, v[122:123], off
L_k1_nopf:
    s_cmp_lt_u32 s2, 448
    s_cbranch_scc1 L_k1_kgen
    s_cmp_lt_u32 s2, 576
    s_cbranch_scc1 L_k1_row
    s_cmp_lt_u32 s2, 704
    s_cbranch_scc1 L_k1_w
    s_endpgm
L_k1_kgen:
    v_lshrrev_b32 v1, 6, v0
    v_and_b32 v2, 63, v0
    v_readfirstlane_b32 s3, v1
    s_lshl_b32 s48, s2, 9
    v_lshl_add_u32 v1, v0, 1, s48
    s_lshr_b32 s15, s2, 1
    s_lshl_b32 s15, s15, 2
    s_waitcnt lgkmcnt(0)
    s_load_dword s50, s[30:31], s15
    global_load_ushort v4, v1, s[18:19]
    global_load_ushort v5, v1, s[20:21]
    global_load_ushort v6, v1, s[22:23]
    global_load_ushort v7, v1, s[24:25]
    global_load_ushort v8, v1, s[26:27]
    global_load_ushort v9, v1, s[28:29]
    s_mov_b32 s8, s46
    s_mov_b32 s9, s47
    s_mov_b32 s10, 0x1200000
    s_mov_b32 s11, 0x20000
    s_mul_i32 s52, s3, 13312
    s_mov_b32 s51, 4096
    v_mov_b32 v12, 53248
    v_mov_b32 v16, 0x3f80
    v_mov_b32 v17, 0x3f80
    v_mov_b32 v18, 0x3f80
    v_mov_b32 v19, 0x3f80
    ds_write_b128 v12, v[16:19]
    v_lshrrev_b32 v10, 2, v2
    v_and_b32 v11, 3, v2
    v_lshl_add_u32 v11, v11, 2, s52
    v_lshl_add_u32 v104, v10, 4, v11
    v_xor_b32 v105, 16, v104
    v_xor_b32 v106, 32, v104
    v_xor_b32 v107, 48, v104
    v_xor_b32 v108, 64, v104
    v_xor_b32 v109, 80, v104
    v_xor_b32 v110, 96, v104
    v_xor_b32 v111, 112, v104
    v_xor_b32 v112, 128, v104
    v_xor_b32 v113, 144, v104
    v_xor_b32 v114, 160, v104
    v_xor_b32 v115, 176, v104
    v_xor_b32 v116, 192, v104
    v_xor_b32 v117, 208, v104
    v_xor_b32 v118, 224, v104
    v_xor_b32 v119, 240, v104
    v_and_b32 v10, 15, v2
    v_lshrrev_b32 v11, 4, v2
    v_lshl_add_u32 v13, v10, 8, s52
    v_cmp_eq_u32 vcc, 0, v10
    v_xor_b32 v14, v11, v10
    v_lshl_add_u32 v100, v14, 4, v13
    v_subrev_u32 v14, 256, v100
    v_xor_b32 v101, 64, v100
    v_xor_b32 v102, 128, v100
    v_xor_b32 v103, 192, v100
    v_cndmask_b32 v96, v14, v12, vcc
    v_xor_b32 v15, 64, v14
    v_cndmask_b32 v97, v15, v12, vcc
    v_xor_b32 v15, 128, v14
    v_cndmask_b32 v98, v15, v12, vcc
    v_xor_b32 v15, 192, v14
    v_cndmask_b32 v99, v15, v12, vcc
    v_lshlrev_b32 v72, 4, v2
    v_add_u32 v73, s52, v72
    s_lshl_b32 s53, s3, 10
    v_add_u32 v72, s53, v72
    s_and_b32 s13, s3, 1
    s_lshl_b32 s54, s13, 4
    v_add_u32 v13, s54, v10
    v_and_b32 v87, 3, v13
    v_lshrrev_b32 v14, 2, v13
    v_lshlrev_b32 v13, 5, v13
    v_lshl_add_u32 v13, v14, 2, v13
    v_add_u32 v13, s51, v13
    s_cmp_lt_u32 s3, 2
    s_cbranch_scc0 L_kg_m1
    v_max_u32 v14, 1, v11
    v_lshlrev_b32_e64 v15, v14, 2
    v_lshlrev_b32 v16, 4, v11
    v_subrev_u32 v17, 1, v11
    v_mul_u32_u24 v17, 1056, v17
    v_cmp_gt_u32 vcc, 2, v11
    s_nop 1
    v_cndmask_b32 v16, v17, v16, vcc
    v_add_u32 v74, v13, v16
    v_add_u32 v75, v74, v15
    v_lshlrev_b32 v17, 1, v15
    v_mov_b32 v18, 1056
    v_cmp_eq_u32 vcc, 3, v11
    s_nop 1
    v_cndmask_b32 v17, v17, v18, vcc
    v_add_u32 v76, v74, v17
    v_add_u32 v77, v76, v15
    v_cmp_eq_u32 vcc, 0, v87
    s_nop 1
    v_cndmask_b32_e64 v87, 4, 8, vcc
    v_sub_u32 v87, v74, v87
    s_branch L_kg_adone
L_kg_m1:
    v_mul_u32_u24 v17, 4224, v11
    v_add_u32 v78, v13, v17
    v_subrev_u32 v88, 128, v0
    v_sub_u32 v89, 69, v88
    v_lshlrev_b32 v89, 3, v89
    v_mov_b32 v90, 1
    v_mov_b32 v16, 2059
    v_mov_b32 v17, 2056
    v_cmp_eq_u32 vcc, 5, v88
    s_nop 1
    v_cndmask_b32 v89, v89, v17, vcc
    v_subrev_u32 v14, 74, v88
    v_mul_u32_u24 v15, 43, v14
    v_lshrrev_b32 v15, 8, v15
    v_mul_u32_u24 v17, 6, v15
    v_sub_u32 v17, v14, v17
    v_lshlrev_b32 v18, 7, v17
    v_sub_u32 v18, 1156, v18
    v_lshl_add_u32 v18, v15, 2, v18
    v_cmp_le_u32 vcc, 74, v88
    s_nop 1
    v_cndmask_b32 v89, v89, v18, vcc
    v_mov_b32 v19, 16
    v_cndmask_b32 v90, v90, v19, vcc
    v_cmp_gt_u32 s[60:61], 2, v17
    s_nop 3
    s_and_b64 s[60:61], s[60:61], vcc
    v_subrev_u32 v14, 100, v88
    v_cmp_le_u32 vcc, 110, v88
    s_nop 1
    v_cndmask_b32_e64 v15, 0, 1, vcc
    v_mul_u32_u24 v17, 10, v15
    v_sub_u32 v17, v14, v17
    v_lshlrev_b32 v18, 7, v17
    v_sub_u32 v18, 1928, v18
    v_lshl_add_u32 v18, v15, 3, v18
    v_cmp_le_u32 vcc, 100, v88
    s_nop 1
    v_cndmask_b32 v89, v89, v18, vcc
    s_nop 0
    s_andn2_b64 s[60:61], s[60:61], vcc
    v_cmp_le_u32 s[62:63], 8, v17
    s_nop 3
    s_and_b64 s[62:63], s[62:63], vcc
    s_or_b64 s[60:61], s[60:61], s[62:63]
    v_cmp_gt_u32 vcc, 5, v88
    s_nop 3
    s_or_b64 s[60:61], s[60:61], vcc
    v_subrev_u32 v14, 70, v88
    v_cmp_gt_u32 vcc, 4, v14
    s_nop 3
    s_or_b64 s[60:61], s[60:61], vcc
    v_subrev_u32 v14, 98, v88
    v_cmp_gt_u32 vcc, 2, v14
    s_nop 3
    s_or_b64 s[60:61], s[60:61], vcc
    v_cmp_le_u32 vcc, 120, v88
    s_nop 3
    s_or_b64 s[60:61], s[60:61], vcc
    v_cndmask_b32 v89, v89, v16, s[60:61]
    v_cndmask_b32_e64 v90, v90, 0, s[60:61]
    v_mad_u32_u24 v14, v90, 7, v89
    v_lshrrev_b32 v15, 5, v14
    v_add_u32 v14, v14, v15
    v_lshl_add_u32 v74, v14, 2, s51
    v_mad_u32_u24 v14, v90, 6, v89
    v_lshrrev_b32 v15, 5, v14
    v_add_u32 v14, v14, v15
    v_lshl_add_u32 v75, v14, 2, s51
    v_mad_u32_u24 v14, v90, 5, v89
    v_lshrrev_b32 v15, 5, v14
    v_add_u32 v14, v14, v15
    v_lshl_add_u32 v76, v14, 2, s51
    v_mad_u32_u24 v14, v90, 4, v89
    v_lshrrev_b32 v15, 5, v14
    v_add_u32 v14, v14, v15
    v_lshl_add_u32 v77, v14, 2, s51
    v_mad_u32_u24 v14, v90, 3, v89
    v_lshrrev_b32 v15, 5, v14
    v_add_u32 v14, v14, v15
    v_lshl_add_u32 v79, v14, 2, s51
    v_mad_u32_u24 v14, v90, 2, v89
    v_lshrrev_b32 v15, 5, v14
    v_add_u32 v14, v14, v15
    v_lshl_add_u32 v91, v14, 2, s51
    v_mad_u32_u24 v14, v90, 1, v89
    v_lshrrev_b32 v15, 5, v14
    v_add_u32 v14, v14, v15
    v_lshl_add_u32 v92, v14, 2, s51
    v_mad_u32_u24 v14, v90, 0, v89
    v_lshrrev_b32 v15, 5, v14
    v_add_u32 v14, v14, v15
    v_lshl_add_u32 v93, v14, 2, s51
L_kg_adone:
    s_waitcnt lgkmcnt(0)
    s_and_b32 s55, s2, 1
    s_lshl_b32 s55, s55, 4
    s_lshr_b32 s50, s50, s55
    s_lshl_b32 s50, s50, 16
    v_mov_b32 v86, s50
    v_mul_f32 v86, 0x3fb8aa3b, v86
    v_exp_f32 v86, v86
    s_nop 0
    v_cvt_pk_bf16_f32 v86, v86, v86
    v_and_b32 v86, 0xffff0000, v86
    s_waitcnt vmcnt(0)
    v_lshlrev_b32 v81, 16, v5
    v_lshlrev_b32 v80, 16, v4
    v_mul_f32 v35, v86, v81
    v_mul_f32 v34, v86, v80
    v_mul_f32 v35, 0.15915494, v35
    v_mul_f32 v34, 0x3fb8aa3b, v34
    v_mul_f32 v61, 0xc1000000, v35
    v_mul_f32 v60, 0x41000000, v34
    v_fract_f32 v61, v61
    v_mul_f32 v63, 0xc3000000, v35
    v_exp_f32 v60, v60
    v_cos_f32 v32, v61
    v_sin_f32 v33, v61
    v_mul_f32 v62, 0x43000000, v34
    v_fract_f32 v63, v63
    v_lshlrev_b32 v82, 16, v6
    v_lshlrev_b32 v83, 16, v7
    v_exp_f32 v62, v62
    v_cos_f32 v48, v63
    v_sin_f32 v49, v63
    v_lshlrev_b32 v84, 16, v8
    v_lshlrev_b32 v85, 16, v9
    v_mul_f32 v82, v86, v82
    v_mul_f32 v83, v86, v83
    v_pk_mul_f32 v[32:33], v[32:33], v[60:61] op_sel_hi:[1,0]
    v_pk_mul_f32 v[50:51], v[84:85], v[82:83] op_sel:[0,0] op_sel_hi:[0,1]
    v_mul_f32 v61, 0x43800000, v35
    v_pk_fma_f32 v[28:29], v[84:85], v[82:83], v[50:51] op_sel:[1,1,0] op_sel_hi:[1,0,1] neg_lo:[0,1,0] neg_hi:[1,0,1]
    v_pk_mul_f32 v[48:49], v[48:49], v[62:63] op_sel_hi:[1,0]
    v_mul_f32 v60, 0x43800000, v34
    v_fract_f32 v61, v61
    v_pk_mul_f32 v[52:53], v[28:29], v[48:49] op_sel:[0,0] op_sel_hi:[0,1]
    v_exp_f32 v60, v60
    v_cos_f32 v22, v61
    v_sin_f32 v23, v61
    v_pk_fma_f32 v[30:31], v[28:29], v[48:49], v[52:53] op_sel:[1,1,0] op_sel_hi:[1,0,1] neg_lo:[0,1,0]
    v_cvt_pk_bf16_f32 v66, v28, v29
    v_cvt_pk_bf16_f32 v67, v30, v31
    v_pk_mul_f32 v[22:23], v[22:23], v[60:61] op_sel_hi:[1,0]
    ds_write2st64_b32 v104, v66, v67 offset0:20 offset1:36
    v_fract_f32 v65, v35
    v_pk_mul_f32 v[58:59], v[22:23], v[22:23] op_sel:[0,0] op_sel_hi:[0,1]
    v_cvt_pk_bf16_f32 v68, v22, v23
    v_exp_f32 v64, v34
    v_cos_f32 v12, v65
    v_sin_f32 v13, v65
    v_pk_fma_f32 v[54:55], v[22:23], v[22:23], v[58:59] op_sel:[1,1,0] op_sel_hi:[1,0,1] neg_lo:[0,1,0]
    ds_write_b32 v112, v68 offset:1792
    v_pk_mul_f32 v[50:51], v[28:29], v[32:33] op_sel:[0,0] op_sel_hi:[0,1]
    v_pk_mul_f32 v[52:53], v[30:31], v[32:33] op_sel:[0,0] op_sel_hi:[0,1]
    v_cvt_pk_bf16_f32 v70, v54, v55
    v_pk_mul_f32 v[12:13], v[12:13], v[64:65] op_sel_hi:[1,0]
    v_pk_fma_f32 v[28:29], v[28:29], v[32:33], v[50:51] op_sel:[1,1,0] op_sel_hi:[1,0,1] neg_lo:[0,1,0]
    v_pk_fma_f32 v[30:31], v[30:31], v[32:33], v[52:53] op_sel:[1,1,0] op_sel_hi:[1,0,1] neg_lo:[0,1,0]
    ds_write_b32 v116, v70 offset:2816
    v_pk_mul_f32 v[26:27], v[12:13], v[12:13] op_sel:[0,0] op_sel_hi:[0,1]
    v_pk_mul_f32 v[58:59], v[54:55], v[54:55] op_sel:[0,0] op_sel_hi:[0,1]
    v_cvt_pk_bf16_f32 v66, v28, v29
    v_cvt_pk_bf16_f32 v67, v30, v31
    v_pk_fma_f32 v[14:15], v[12:13], v[12:13], v[26:27] op_sel:[1,1,0] op_sel_hi:[1,0,1] neg_lo:[0,1,0]
    v_pk_fma_f32 v[56:57], v[54:55], v[54:55], v[58:59] op_sel:[1,1,0] op_sel_hi:[1,0,1] neg_lo:[0,1,0]
    ds_write2st64_b32 v105, v66, v67 offset0:21 offset1:37
    v_pk_mul_f32 v[26:27], v[14:15], v[14:15] op_sel:[0,0] op_sel_hi:[0,1]
    v_pk_mul_f32 v[50:51], v[28:29], v[32:33] op_sel:[0,0] op_sel_hi:[0,1]
    v_pk_mul_f32 v[52:53], v[30:31], v[32:33] op_sel:[0,0] op_sel_hi:[0,1]
    v_cvt_pk_bf16_f32 v68, v56, v57
    v_pk_fma_f32 v[18:19], v[14:15], v[14:15], v[26:27] op_sel:[1,1,0] op_sel_hi:[1,0,1] neg_lo:[0,1,0]
    v_pk_fma_f32 v[28:29], v[28:29], v[32:33], v[50:51] op_sel:[1,1,0] op_sel_hi:[1,0,1] neg_lo:[0,1,0]
    v_pk_fma_f32 v[30:31], v[30:31], v[32:33], v[52:53] op_sel:[1,1,0] op_sel_hi:[1,0,1] neg_lo:[0,1,0]
    ds_write_b32 v104, v68 offset:3840
    v_pk_mul_f32 v[26:27], v[54:55], v[18:19] op_sel:[0,0] op_sel_hi:[0,1]
    v_cvt_pk_bf16_f32 v70, v28, v29
    v_cvt_pk_bf16_f32 v71, v30, v31
    v_pk_fma_f32 v[24:25], v[54:55], v[18:19], v[26:27] op_sel:[1,1,0] op_sel_hi:[1,0,1] neg_lo:[0,1,0]
    ds_write2st64_b32 v106, v70, v71 offset0:22 offset1:38
    v_pk_mul_f32 v[50:51], v[28:29], v[32:33] op_sel:[0,0] op_sel_hi:[0,1]
    v_pk_mul_f32 v[52:53], v[30:31], v[32:33] op_sel:[0,0] op_sel_hi:[0,1]
    v_cvt_pk_bf16_f32 v66, v24, v25
    v_pk_fma_f32 v[28:29], v[28:29], v[32:33], v[50:51] op_sel:[1,1,0] op_sel_hi:[1,0,1] neg_lo:[0,1,0]
    v_pk_fma_f32 v[30:31], v[30:31], v[32:33], v[52:53] op_sel:[1,1,0] op_sel_hi:[1,0,1] neg_lo:[0,1,0]
    ds_write_b32 v117, v66 offset:3072
    v_pk_mul_f32 v[58:59], v[54:55], v[22:23] op_sel:[0,0] op_sel_hi:[0,1]
    v_cvt_pk_bf16_f32 v68, v28, v29
    v_cvt_pk_bf16_f32 v69, v30, v31
    v_pk_fma_f32 v[54:55], v[54:55], v[22:23], v[58:59] op_sel:[1,1,0] op_sel_hi:[1,0,1] neg_lo:[0,1,0]
    ds_write2st64_b32 v107, v68, v69 offset0:23 offset1:39
    v_pk_mul_f32 v[50:51], v[28:29], v[32:33] op_sel:[0,0] op_sel_hi:[0,1]
    v_pk_mul_f32 v[52:53], v[30:31], v[32:33] op_sel:[0,0] op_sel_hi:[0,1]
    v_cvt_pk_bf16_f32 v70, v54, v55
    v_pk_fma_f32 v[28:29], v[28:29], v[32:33], v[50:51] op_sel:[1,1,0] op_sel_hi:[1,0,1] neg_lo:[0,1,0]
    v_pk_fma_f32 v[30:31], v[30:31], v[32:33], v[52:53] op_sel:[1,1,0] op_sel_hi:[1,0,1] neg_lo:[0,1,0]
    ds_write_b32 v118, v70 offset:3328
    v_pk_mul_f32 v[58:59], v[56:57], v[22:23] op_sel:[0,0] op_sel_hi:[0,1]
    v_cvt_pk_bf16_f32 v66, v28, v29
    v_cvt_pk_bf16_f32 v67, v30, v31
    v_pk_fma_f32 v[56:57], v[56:57], v[22:23], v[58:59] op_sel:[1,1,0] op_sel_hi:[1,0,1] neg_lo:[0,1,0]
    ds_write2st64_b32 v108, v66, v67 offset0:24 offset1:40
    v_pk_mul_f32 v[50:51], v[28:29], v[32:33] op_sel:[0,0] op_sel_hi:[0,1]
    v_pk_mul_f32 v[52:53], v[30:31], v[32:33] op_sel:[0,0] op_sel_hi:[0,1]
    v_cvt_pk_bf16_f32 v68, v12, v13
    v_cvt_pk_bf16_f32 v69, v56, v57
    v_pk_fma_f32 v[28:29], v[28:29], v[32:33], v[50:51] op_sel:[1,1,0] op_sel_hi:[1,0,1] neg_lo:[0,1,0]
    v_pk_fma_f32 v[30:31], v[30:31], v[32:33], v[52:53] op_sel:[1,1,0] op_sel_hi:[1,0,1] neg_lo:[0,1,0]
    ds_write2st64_b32 v105, v68, v69 offset0:0 offset1:16
    v_pk_mul_f32 v[26:27], v[54:55], v[18:19] op_sel:[0,0] op_sel_hi:[0,1]
    v_cvt_pk_bf16_f32 v70, v28, v29
    v_cvt_pk_bf16_f32 v71, v30, v31
    v_pk_fma_f32 v[24:25], v[54:55], v[18:19], v[26:27] op_sel:[1,1,0] op_sel_hi:[1,0,1] neg_lo:[0,1,0]
    ds_write2st64_b32 v109, v70, v71 offset0:25 offset1:41
    v_pk_mul_f32 v[50:51], v[28:29], v[32:33] op_sel:[0,0] op_sel_hi:[0,1]
    v_pk_mul_f32 v[52:53], v[30:31], v[32:33] op_sel:[0,0] op_sel_hi:[0,1]
    v_cvt_pk_bf16_f32 v66, v24, v25
    v_pk_fma_f32 v[28:29], v[28:29], v[32:33], v[50:51] op_sel:[1,1,0] op_sel_hi:[1,0,1] neg_lo:[0,1,0]
    v_pk_fma_f32 v[30:31], v[30:31], v[32:33], v[52:53] op_sel:[1,1,0] op_sel_hi:[1,0,1] neg_lo:[0,1,0]
    ds_write_b32 v119, v66 offset:3584
    v_pk_mul_f32 v[58:59], v[56:57], v[22:23] op_sel:[0,0] op_sel_hi:[0,1]
    v_cvt_pk_bf16_f32 v68, v28, v29
    v_cvt_pk_bf16_f32 v69, v30, v31
    v_pk_fma_f32 v[56:57], v[56:57], v[22:23], v[58:59] op_sel:[1,1,0] op_sel_hi:[1,0,1] neg_lo:[0,1,0]
    ds_write2st64_b32 v110, v68, v69 offset0:26 offset1:42
    v_pk_mul_f32 v[50:51], v[28:29], v[32:33] op_sel:[0,0] op_sel_hi:[0,1]
    v_pk_mul_f32 v[52:53], v[30:31], v[32:33] op_sel:[0,0] op_sel_hi:[0,1]
    v_cvt_pk_bf16_f32 v70, v14, v15
    v_cvt_pk_bf16_f32 v71, v56, v57
    v_pk_fma_f32 v[28:29], v[28:29], v[32:33], v[50:51] op_sel:[1,1,0] op_sel_hi:[1,0,1] neg_lo:[0,1,0]
    v_pk_fma_f32 v[30:31], v[30:31], v[32:33], v[52:53] op_sel:[1,1,0] op_sel_hi:[1,0,1] neg_lo:[0,1,0]
    v_pk_mul_f32 v[26:27], v[14:15], v[12:13] op_sel:[0,0] op_sel_hi:[0,1]
    v_pk_mul_f32 v[58:59], v[56:57], v[22:23] op_sel:[0,0] op_sel_hi:[0,1]
    v_cvt_pk_bf16_f32 v66, v28, v29
    v_cvt_pk_bf16_f32 v67, v30, v31
    v_pk_fma_f32 v[16:17], v[14:15], v[12:13], v[26:27] op_sel:[1,1,0] op_sel_hi:[1,0,1] neg_lo:[0,1,0]
    v_pk_fma_f32 v[56:57], v[56:57], v[22:23], v[58:59] op_sel:[1,1,0] op_sel_hi:[1,0,1] neg_lo:[0,1,0]
    v_pk_mul_f32 v[50:51], v[28:29], v[32:33] op_sel:[0,0] op_sel_hi:[0,1]
    v_pk_mul_f32 v[52:53], v[30:31], v[32:33] op_sel:[0,0] op_sel_hi:[0,1]
    v_cvt_pk_bf16_f32 v68, v16, v17
    v_cvt_pk_bf16_f32 v69, v56, v57
    v_pk_fma_f32 v[28:29], v[28:29], v[32:33], v[50:51] op_sel:[1,1,0] op_sel_hi:[1,0,1] neg_lo:[0,1,0]
    v_pk_fma_f32 v[30:31], v[30:31], v[32:33], v[52:53] op_sel:[1,1,0] op_sel_hi:[1,0,1] neg_lo:[0,1,0]
    v_pk_mul_f32 v[58:59], v[56:57], v[22:23] op_sel:[0,0] op_sel_hi:[0,1]
    v_pk_fma_f32 v[56:57], v[56:57], v[22:23], v[58:59] op_sel:[1,1,0] op_sel_hi:[1,0,1] neg_lo:[0,1,0]
    v_pk_mul_f32 v[50:51], v[28:29], v[32:33] op_sel:[0,0] op_sel_hi:[0,1]
    v_pk_mul_f32 v[52:53], v[30:31], v[32:33] op_sel:[0,0] op_sel_hi:[0,1]
    v_pk_mul_f32 v[26:27], v[18:19], v[12:13] op_sel:[0,0] op_sel_hi:[0,1]
    v_pk_fma_f32 v[24:25], v[18:19], v[12:13], v[26:27] op_sel:[1,1,0] op_sel_hi:[1,0,1] neg_lo:[0,1,0]
    v_pk_mul_f32 v[26:27], v[18:19], v[14:15] op_sel:[0,0] op_sel_hi:[0,1]
    v_pk_fma_f32 v[20:21], v[18:19], v[14:15], v[26:27] op_sel:[1,1,0] op_sel_hi:[1,0,1] neg_lo:[0,1,0]
    v_pk_mul_f32 v[26:27], v[18:19], v[16:17] op_sel:[0,0] op_sel_hi:[0,1]
    s_waitcnt lgkmcnt(13)
    ds_write2st64_b32 v106, v70, v71 offset0:1 offset1:17
    v_cvt_pk_bf16_f32 v70, v28, v29
    v_cvt_pk_bf16_f32 v71, v30, v31
    v_pk_fma_f32 v[28:29], v[28:29], v[32:33], v[50:51] op_sel:[1,1,0] op_sel_hi:[1,0,1] neg_lo:[0,1,0]
    v_pk_fma_f32 v[30:31], v[30:31], v[32:33], v[52:53] op_sel:[1,1,0] op_sel_hi:[1,0,1] neg_lo:[0,1,0]
    v_pk_mul_f32 v[50:51], v[28:29], v[32:33] op_sel:[0,0] op_sel_hi:[0,1]
    v_pk_mul_f32 v[52:53], v[30:31], v[32:33] op_sel:[0,0] op_sel_hi:[0,1]
    s_waitcnt lgkmcnt(13)
    ds_write2st64_b32 v111, v66, v67 offset0:27 offset1:43
    v_cvt_pk_bf16_f32 v66, v18, v19
    v_cvt_pk_bf16_f32 v67, v56, v57
    s_waitcnt lgkmcnt(13)
    ds_write2st64_b32 v107, v68, v69 offset0:2 offset1:18
    v_cvt_pk_bf16_f32 v68, v28, v29
    v_cvt_pk_bf16_f32 v69, v30, v31
    v_pk_fma_f32 v[28:29], v[28:29], v[32:33], v[50:51] op_sel:[1,1,0] op_sel_hi:[1,0,1] neg_lo:[0,1,0]
    v_pk_fma_f32 v[30:31], v[30:31], v[32:33], v[52:53] op_sel:[1,1,0] op_sel_hi:[1,0,1] neg_lo:[0,1,0]
    v_pk_mul_f32 v[50:51], v[28:29], v[32:33] op_sel:[0,0] op_sel_hi:[0,1]
    v_pk_mul_f32 v[52:53], v[30:31], v[32:33] op_sel:[0,0] op_sel_hi:[0,1]
    s_waitcnt lgkmcnt(13)
    ds_write2st64_b32 v112, v70, v71 offset0:28 offset1:44
    v_cvt_pk_bf16_f32 v70, v24, v25
    v_pk_fma_f32 v[24:25], v[18:19], v[16:17], v[26:27] op_sel:[1,1,0] op_sel_hi:[1,0,1] neg_lo:[0,1,0]
    v_pk_mul_f32 v[26:27], v[22:23], v[14:15] op_sel:[0,0] op_sel_hi:[0,1]
    s_waitcnt lgkmcnt(13)
    ds_write2st64_b32 v108, v66, v67 offset0:3 offset1:19
    v_cvt_pk_bf16_f32 v66, v28, v29
    v_cvt_pk_bf16_f32 v67, v30, v31
    v_pk_fma_f32 v[28:29], v[28:29], v[32:33], v[50:51] op_sel:[1,1,0] op_sel_hi:[1,0,1] neg_lo:[0,1,0]
    v_pk_fma_f32 v[30:31], v[30:31], v[32:33], v[52:53] op_sel:[1,1,0] op_sel_hi:[1,0,1] neg_lo:[0,1,0]
    v_cvt_pk_bf16_f32 v71, v30, v31
    v_pk_mul_f32 v[50:51], v[28:29], v[32:33] op_sel:[0,0] op_sel_hi:[0,1]
    v_pk_mul_f32 v[52:53], v[30:31], v[32:33] op_sel:[0,0] op_sel_hi:[0,1]
    v_pk_fma_f32 v[30:31], v[30:31], v[32:33], v[52:53] op_sel:[1,1,0] op_sel_hi:[1,0,1] neg_lo:[0,1,0]
    v_pk_mul_f32 v[52:53], v[30:31], v[32:33] op_sel:[0,0] op_sel_hi:[0,1]
    s_waitcnt lgkmcnt(13)
    ds_write2st64_b32 v113, v68, v69 offset0:29 offset1:45
    v_cvt_pk_bf16_f32 v68, v20, v21
    v_cvt_pk_bf16_f32 v69, v30, v31
    v_pk_fma_f32 v[30:31], v[30:31], v[32:33], v[52:53] op_sel:[1,1,0] op_sel_hi:[1,0,1] neg_lo:[0,1,0]
    v_pk_mul_f32 v[52:53], v[30:31], v[32:33] op_sel:[0,0] op_sel_hi:[0,1]
    s_waitcnt lgkmcnt(13)
    ds_write_b32 v109, v70 offset:1024
    v_cvt_pk_bf16_f32 v70, v28, v29
    v_pk_fma_f32 v[28:29], v[28:29], v[32:33], v[50:51] op_sel:[1,1,0] op_sel_hi:[1,0,1] neg_lo:[0,1,0]
    v_pk_mul_f32 v[50:51], v[28:29], v[32:33] op_sel:[0,0] op_sel_hi:[0,1]
    s_waitcnt lgkmcnt(13)
    ds_write2st64_b32 v114, v66, v67 offset0:30 offset1:46
    v_cvt_pk_bf16_f32 v66, v24, v25
    v_pk_fma_f32 v[24:25], v[22:23], v[14:15], v[26:27] op_sel:[1,1,0] op_sel_hi:[1,0,1] neg_lo:[0,1,0]
    v_pk_mul_f32 v[26:27], v[22:23], v[18:19] op_sel:[0,0] op_sel_hi:[0,1]
    v_cvt_pk_bf16_f32 v67, v30, v31
    v_pk_fma_f32 v[30:31], v[30:31], v[32:33], v[52:53] op_sel:[1,1,0] op_sel_hi:[1,0,1] neg_lo:[0,1,0]
    v_pk_mul_f32 v[52:53], v[30:31], v[32:33] op_sel:[0,0] op_sel_hi:[0,1]
    s_waitcnt lgkmcnt(13)
    ds_write_b32 v110, v68 offset:1280
    v_cvt_pk_bf16_f32 v68, v28, v29
    v_pk_fma_f32 v[28:29], v[28:29], v[32:33], v[50:51] op_sel:[1,1,0] op_sel_hi:[1,0,1] neg_lo:[0,1,0]
    v_pk_mul_f32 v[50:51], v[28:29], v[32:33] op_sel:[0,0] op_sel_hi:[0,1]
    s_waitcnt lgkmcnt(13)
    ds_write2st64_b32 v115, v70, v71 offset0:31 offset1:47
    v_cvt_pk_bf16_f32 v70, v24, v25
    v_pk_fma_f32 v[24:25], v[22:23], v[18:19], v[26:27] op_sel:[1,1,0] op_sel_hi:[1,0,1] neg_lo:[0,1,0]
    v_pk_mul_f32 v[26:27], v[22:23], v[20:21] op_sel:[0,0] op_sel_hi:[0,1]
    v_cvt_pk_bf16_f32 v71, v30, v31
    v_pk_fma_f32 v[30:31], v[30:31], v[32:33], v[52:53] op_sel:[1,1,0] op_sel_hi:[1,0,1] neg_lo:[0,1,0]
    s_waitcnt lgkmcnt(13)
    ds_write_b32 v111, v66 offset:1536
    v_cvt_pk_bf16_f32 v66, v28, v29
    v_pk_fma_f32 v[28:29], v[28:29], v[32:33], v[50:51] op_sel:[1,1,0] op_sel_hi:[1,0,1] neg_lo:[0,1,0]
    v_pk_mul_f32 v[50:51], v[28:29], v[32:33] op_sel:[0,0] op_sel_hi:[0,1]
    s_waitcnt lgkmcnt(13)
    ds_write2st64_b32 v116, v68, v69 offset0:32 offset1:48
    v_cvt_pk_bf16_f32 v68, v24, v25
    v_pk_fma_f32 v[24:25], v[22:23], v[20:21], v[26:27] op_sel:[1,1,0] op_sel_hi:[1,0,1] neg_lo:[0,1,0]
    v_cvt_pk_bf16_f32 v69, v30, v31
    s_waitcnt lgkmcnt(13)
    ds_write_b32 v113, v70 offset:2048
    v_cvt_pk_bf16_f32 v70, v28, v29
    v_pk_fma_f32 v[28:29], v[28:29], v[32:33], v[50:51] op_sel:[1,1,0] op_sel_hi:[1,0,1] neg_lo:[0,1,0]
    s_waitcnt lgkmcnt(13)
    ds_write2st64_b32 v117, v66, v67 offset0:33 offset1:49
    v_cvt_pk_bf16_f32 v66, v24, v25
    s_waitcnt lgkmcnt(13)
    ds_write_b32 v114, v68 offset:2304
    v_cvt_pk_bf16_f32 v68, v28, v29
    s_waitcnt lgkmcnt(13)
    ds_write2st64_b32 v118, v70, v71 offset0:34 offset1:50
    s_waitcnt lgkmcnt(13)
    ds_write_b32 v115, v66 offset:2560
    s_waitcnt lgkmcnt(13)
    ds_write2st64_b32 v119, v68, v69 offset0:35 offset1:51
    s_waitcnt lgkmcnt(13)
    ds_read_b128 v[12:15], v96
    s_waitcnt lgkmcnt(13)
    ds_read_b128 v[16:19], v100 offset:3840
    s_waitcnt lgkmcnt(13)
    ds_read_b128 v[20:23], v100 offset:5120
    s_waitcnt lgkmcnt(13)
    ds_read_b128 v[24:27], v100 offset:9216
    s_waitcnt lgkmcnt(13)
    ds_read_b128 v[48:51], v97
    s_waitcnt lgkmcnt(13)
    ds_read_b128 v[52:55], v101 offset:3840
    s_waitcnt lgkmcnt(13)
    ds_read_b128 v[56:59], v101 offset:5120
    s_waitcnt lgkmcnt(13)
    ds_read_b128 v[60:63], v101 offset:9216
    s_waitcnt lgkmcnt(5)
    v_mfma_f32_16x16x32_bf16 v[40:43], v[12:15], v[20:23], 0
    s_waitcnt lgkmcnt(4)
    v_mfma_f32_16x16x32_bf16 v[44:47], v[12:15], v[24:27], 0
    ds_read_b128 v[12:15], v98
    v_mfma_f32_16x16x32_bf16 v[120:123], v[16:19], v[20:23], 0
    ds_read_b128 v[20:23], v102 offset:5120
    v_mfma_f32_16x16x32_bf16 v[124:127], v[16:19], v[24:27], 0
    ds_read_b128 v[24:27], v102 offset:9216
    ds_read_b128 v[16:19], v102 offset:3840
    s_waitcnt lgkmcnt(5)
    v_mfma_f32_16x16x32_bf16 v[40:43], v[48:51], v[56:59], v[40:43]
    s_waitcnt lgkmcnt(4)
    v_mfma_f32_16x16x32_bf16 v[44:47], v[48:51], v[60:63], v[44:47]
    ds_read_b128 v[48:51], v99
    v_mfma_f32_16x16x32_bf16 v[120:123], v[52:55], v[56:59], v[120:123]
    ds_read_b128 v[56:59], v103 offset:5120
    v_mfma_f32_16x16x32_bf16 v[124:127], v[52:55], v[60:63], v[124:127]
    ds_read_b128 v[60:63], v103 offset:9216
    ds_read_b128 v[52:55], v103 offset:3840
    s_waitcnt lgkmcnt(6)
    v_mfma_f32_16x16x32_bf16 v[40:43], v[12:15], v[20:23], v[40:43]
    s_waitcnt lgkmcnt(5)
    v_mfma_f32_16x16x32_bf16 v[44:47], v[12:15], v[24:27], v[44:47]
    s_waitcnt lgkmcnt(4)
    v_mfma_f32_16x16x32_bf16 v[120:123], v[16:19], v[20:23], v[120:123]
    v_mfma_f32_16x16x32_bf16 v[124:127], v[16:19], v[24:27], v[124:127]
    s_waitcnt lgkmcnt(2)
    v_mfma_f32_16x16x32_bf16 v[40:43], v[48:51], v[56:59], v[40:43]
    s_waitcnt lgkmcnt(1)
    v_mfma_f32_16x16x32_bf16 v[44:47], v[48:51], v[60:63], v[44:47]
    s_waitcnt lgkmcnt(0)
    v_mfma_f32_16x16x32_bf16 v[120:123], v[52:55], v[56:59], v[120:123]
    s_nop 3
    ds_write_b128 v73, v[40:43] offset:0
    v_mfma_f32_16x16x32_bf16 v[124:127], v[52:55], v[60:63], v[124:127]
    ds_write_b128 v73, v[44:47] offset:1024
    s_nop 0
    ds_write_b128 v73, v[120:123] offset:2048
    s_nop 4
    ds_write_b128 v73, v[124:127] offset:3072
    s_waitcnt lgkmcnt(0)
    s_barrier
    ds_read_b128 v[12:15], v72 offset:0
    ds_read_b128 v[16:19], v72 offset:13312
    ds_read_b128 v[20:23], v72 offset:26624
    ds_read_b128 v[24:27], v72 offset:39936
    s_waitcnt lgkmcnt(2)
    v_add_f32 v40, v12, v16
    v_add_f32 v41, v13, v17
    v_add_f32 v42, v14, v18
    v_add_f32 v43, v15, v19
    s_waitcnt lgkmcnt(0)
    v_add_f32 v44, v20, v24
    v_add_f32 v45, v21, v25
    v_add_f32 v46, v22, v26
    v_add_f32 v47, v23, v27
    v_add_f32 v40, v40, v44
    v_add_f32 v41, v41, v45
    v_add_f32 v42, v42, v46
    v_add_f32 v43, v43, v47
    s_cmp_lt_u32 s3, 2
    s_cbranch_scc0 L_kg_t2m1
    ds_write_b32 v74, v40
    ds_write_b32 v75, v41
    ds_write_b32 v76, v42
    ds_write_b32 v77, v43
    s_mov_b32 exec_lo, 0
    s_mov_b32 exec_hi, 0xffff
    ds_write_b32 v74, v40 offset:4
    v_subrev_u32 v14, 4, v76
    ds_write_b32 v76, v42 offset:4
    ds_write_b32 v14, v42
    s_cmp_eq_u32 s3, 0
    s_cselect_b32 exec_hi, 0xfffe, exec_hi
    ds_write_b32 v87, v40
    s_mov_b64 exec, -1
    s_cmp_eq_u32 s3, 0
    s_cbranch_scc0 L_kg_t2done
    v_mov_b32 v14, s51
    v_mov_b32 v15, 0
    s_mov_b32 exec_lo, 0
    s_mov_b32 exec_hi, 0x10000
    ds_write_b32 v14, v40 offset:2104
    ds_write_b32 v14, v40 offset:8480
    ds_write_b32 v14, v40 offset:8484
    ds_write_b32 v14, v40 offset:8488
    ds_write_b32 v14, v15 offset:8492
    ds_write_b32 v14, v15 offset:8496
    ds_write_b32 v14, v15 offset:8500
    ds_write_b32 v14, v15 offset:8504
    ds_write_b32 v14, v15 offset:8508
    s_mov_b64 exec, -1
    s_branch L_kg_t2done
L_kg_t2m1:
    s_mov_b32 exec_hi, 0
    s_cmp_eq_u32 s3, 2
    s_mov_b32 exec_lo, 0xffff
    s_cbranch_scc0 L_kg_m1a
    s_mov_b32 exec_lo, 0x1ffff
L_kg_m1a:
    ds_write_b32 v78, v40 offset:4224
    s_mov_b32 exec_lo, 0xffff
    ds_write_b32 v78, v41 offset:5280
    ds_write_b32 v78, v42 offset:6336
    ds_write_b32 v78, v43 offset:7392
    s_mov_b64 exec, -1
L_kg_t2done:
    s_waitcnt lgkmcnt(0)
    s_barrier
    s_cmp_lt_u32 s3, 2
    s_cbranch_scc1 L_kg_end1
    s_mul_i32 s58, s2, 2048
    s_add_u32 s58, s58, 0x600000
    v_lshl_add_u32 v19, v88, 4, s58
    v_cmp_gt_u32 vcc, 120, v88
    ds_read_b32 v24, v74
    ds_read_b32 v25, v75
    ds_read_b32 v26, v76
    ds_read_b32 v27, v77
    ds_read_b32 v28, v79
    ds_read_b32 v29, v91
    ds_read_b32 v30, v92
    ds_read_b32 v31, v93
    s_and_b64 exec, exec, vcc
    s_waitcnt lgkmcnt(6)
    v_cvt_pk_bf16_f32 v56, v24, v25
    s_waitcnt lgkmcnt(4)
    v_cvt_pk_bf16_f32 v57, v26, v27
    s_waitcnt lgkmcnt(2)
    v_cvt_pk_bf16_f32 v58, v28, v29
    s_waitcnt lgkmcnt(0)
    v_cvt_pk_bf16_f32 v59, v30, v31
    buffer_store_dwordx4 v[56:59], v19, s[8:11], 0 offen sc1
L_kg_end1:
    s_endpgm
L_k1_row:
    v_lshrrev_b32 v1, 6, v0
    v_and_b32 v2, 63, v0
    v_readfirstlane_b32 s3, v1
    s_sub_u32 s12, s2, 448
    s_lshl_b32 s12, s12, 4
    s_nop 1
    s_lshl_b32 s13, s3, 2
    s_add_u32 s14, s12, s13
    s_mul_i32 s15, s14, 896
    v_lshl_add_u32 v3, v2, 4, s15
    v_lshlrev_b32 v4, 4, v2
    s_waitcnt lgkmcnt(0)
    s_mov_b32 exec_hi, 0x00ffffff
    global_load_dwordx4 v[8:11], v3, s[16:17] offset:0
    global_load_dwordx4 v[12:15], v3, s[16:17] offset:896
    global_load_dwordx4 v[16:19], v3, s[16:17] offset:1792
    global_load_dwordx4 v[20:23], v3, s[16:17] offset:2688
    global_load_dwordx4 v[24:27], v4, s[40:41]
    s_mov_b64 exec, -1
    s_mov_b32 s8, s46
    s_mov_b32 s9, s47
    s_mov_b32 s10, 0x1200000
    s_mov_b32 s11, 0x20000
    v_and_b32 v5, 15, v2
    v_lshrrev_b32 v6, 4, v2
    v_cvt_f32_u32 v28, v5
    v_lshlrev_b32 v7, 2, v6
    v_cvt_f32_u32 v29, v7
    v_mul_f32 v30, 0xbd124925, v28
    v_mul_f32 v59, v29, v30
    v_cos_f32 v40, v59
    v_sin_f32 v48, v59
    v_fmamk_f32 v31, v30, 0x3f800000, v59
    v_cos_f32 v41, v31
    v_sin_f32 v49, v31
    v_fmamk_f32 v31, v30, 0x40000000, v59
    v_cos_f32 v42, v31
    v_sin_f32 v50, v31
    v_fmamk_f32 v31, v30, 0x40400000, v59
    v_cos_f32 v43, v31
    v_sin_f32 v51, v31
    v_fmamk_f32 v31, v30, 0x41800000, v59
    v_cos_f32 v44, v31
    v_sin_f32 v52, v31
    v_fmamk_f32 v31, v30, 0x41880000, v59
    v_cos_f32 v45, v31
    v_sin_f32 v53, v31
    v_fmamk_f32 v31, v30, 0x41900000, v59
    v_cos_f32 v46, v31
    v_sin_f32 v54, v31
    v_fmamk_f32 v31, v30, 0x41980000, v59
    v_cos_f32 v47, v31
    v_sin_f32 v55, v31
    v_cvt_pk_bf16_f32 v32, v40, v41
    v_cvt_pk_bf16_f32 v36, v48, v49
    v_cvt_pk_bf16_f32 v33, v42, v43
    v_cvt_pk_bf16_f32 v37, v50, v51
    v_cvt_pk_bf16_f32 v34, v44, v45
    v_cvt_pk_bf16_f32 v38, v52, v53
    v_cvt_pk_bf16_f32 v35, v46, v47
    v_cvt_pk_bf16_f32 v39, v54, v55
    v_cmp_gt_u32 vcc, 3, v6
    s_nop 1
    v_cndmask_b32 v34, 0, v34, vcc
    v_cndmask_b32 v35, 0, v35, vcc
    v_cndmask_b32 v38, 0, v38, vcc
    v_cndmask_b32 v39, 0, v39, vcc
    v_mul_f32 v30, 0xbb124925, v28
    v_mul_f32 v59, v29, v30
    v_cos_f32 v40, v59
    v_sin_f32 v44, v59
    v_fmamk_f32 v31, v30, 0x3f800000, v59
    v_cos_f32 v41, v31
    v_sin_f32 v45, v31
    v_fmamk_f32 v31, v30, 0x40000000, v59
    v_cos_f32 v42, v31
    v_sin_f32 v46, v31
    v_fmamk_f32 v31, v30, 0x40400000, v59
    v_cos_f32 v43, v31
    v_sin_f32 v47, v31
    v_mul_f32 v30, 0xbd800000, v28
    v_mul_f32 v59, v29, v30
    v_cos_f32 v56, v59
    v_sin_f32 v57, v59
    s_nop 0
    v_cvt_pk_bf16_f32 v48, v56, -v57
    v_cvt_pk_bf16_f32 v52, v57, v56
    v_fmamk_f32 v31, v30, 0x3f800000, v59
    v_cos_f32 v56, v31
    v_sin_f32 v57, v31
    s_nop 0
    v_cvt_pk_bf16_f32 v49, v56, -v57
    v_cvt_pk_bf16_f32 v53, v57, v56
    v_fmamk_f32 v31, v30, 0x40000000, v59
    v_cos_f32 v56, v31
    v_sin_f32 v57, v31
    s_nop 0
    v_cvt_pk_bf16_f32 v50, v56, -v57
    v_cvt_pk_bf16_f32 v54, v57, v56
    v_fmamk_f32 v31, v30, 0x40400000, v59
    v_cos_f32 v56, v31
    v_sin_f32 v57, v31
    s_nop 0
    v_cvt_pk_bf16_f32 v51, v56, -v57
    v_cvt_pk_bf16_f32 v55, v57, v56
    s_mul_i32 s48, s13, 928
    v_add_u32 v56, s48, v4
    s_mul_i32 s49, s3, 896
    s_add_u32 s49, s49, 14848
    v_add_u32 v57, s49, v4
    v_lshlrev_b32 v58, 3, v2
    v_add_u32 v58, s48, v58
    v_cmp_le_u32 vcc, 48, v2
    v_mov_b32 v59, 512
    v_mov_b32 v60, 384
    v_cndmask_b32 v59, v59, v60, vcc
    v_add_u32 v59, v58, v59
    v_mul_u32_u24 v60, 928, v5
    v_lshl_add_u32 v60, v6, 4, v60
    v_lshlrev_b32 v61, 4, v6
    v_add_u32 v61, s49, v61
    v_mul_u32_u24 v62, 1040, v5
    v_lshl_add_u32 v62, v6, 8, v62
    s_lshl_b32 s51, s3, 4
    s_add_u32 s51, s51, 18432
    v_add_u32 v62, s51, v62
    s_mul_i32 s51, s3, 1040
    s_add_u32 s51, s51, 18432
    v_add_u32 v65, s51, v4
    s_lshr_b32 s50, s12, 4
    s_mul_i32 s50, s50, 16640
    s_lshl_b32 s51, s3, 10
    s_add_u32 s50, s50, s51
    s_add_u32 s50, s50, 0x0
    v_add_u32 v66, s50, v4
    v_and_b32 v63, 1, v6
    v_lshlrev_b32 v63, 3, v63
    v_lshrrev_b32 v64, 2, v5
    v_add_u32 v63, v63, v64
    v_mul_u32_u24 v63, 928, v63
    v_lshrrev_b32 v64, 1, v6
    v_lshl_add_u32 v63, v64, 5, v63
    v_and_b32 v67, 3, v2
    v_lshl_add_u32 v63, v67, 3, v63
    s_lshl_b32 s51, s3, 6
    v_add_u32 v63, s51, v63
    v_lshl_add_u32 v64, v64, 4, v5
    v_lshlrev_b32 v64, 5, v64
    v_and_b32 v67, 1, v6
    v_lshl_add_u32 v64, v67, 4, v64
    s_lshr_b32 s51, s12, 4
    s_mul_i32 s51, s51, 14592
    s_lshl_b32 s55, s3, 10
    s_add_u32 s51, s51, s55
    s_add_u32 s51, s51, 0x300000
    v_add_u32 v64, s51, v64
    s_mov_b32 s68, 4096
    s_mov_b32 s69, 8192
    s_mov_b32 s70, 12288
    s_cmp_lt_u32 s3, 2
    s_cselect_b32 s70, s70, 0x7ff00000
    s_waitcnt vmcnt(0)
    s_mov_b32 exec_hi, 0x00ffffff
    ds_write_b128 v56, v[8:11] offset:0
    ds_write_b128 v56, v[12:15] offset:928
    ds_write_b128 v56, v[16:19] offset:1856
    ds_write_b128 v56, v[20:23] offset:2784
    ds_write_b128 v57, v[24:27]
    s_mov_b64 exec, -1
    ds_read_b64_tr_b16 v[8:9], v58 offset:0
    ds_read_b64_tr_b16 v[10:11], v59 offset:0
    ds_read_b64_tr_b16 v[12:13], v58 offset:928
    ds_read_b64_tr_b16 v[14:15], v59 offset:928
    ds_read_b64_tr_b16 v[16:17], v58 offset:1856
    ds_read_b64_tr_b16 v[18:19], v59 offset:1856
    ds_read_b64_tr_b16 v[20:21], v58 offset:2784
    ds_read_b64_tr_b16 v[22:23], v59 offset:2784
    s_waitcnt lgkmcnt(0)
    s_barrier
    v_mfma_f32_16x16x32_bf16 v[68:71], v[8:11], v[32:35], 0
    ds_read_b64_tr_b16 v[100:101], v63 offset:0
    ds_read_b64_tr_b16 v[102:103], v63 offset:3712
    v_mfma_f32_16x16x32_bf16 v[72:75], v[12:15], v[32:35], 0
    ds_read_b64_tr_b16 v[104:105], v63 offset:256
    ds_read_b64_tr_b16 v[106:107], v63 offset:3968
    v_mfma_f32_16x16x32_bf16 v[84:87], v[8:11], v[36:39], 0
    ds_read_b64_tr_b16 v[108:109], v63 offset:512
    s_nop 0
    v_mul_f32 v28, v68, v40
    v_mfma_f32_16x16x32_bf16 v[88:91], v[12:15], v[36:39], 0
    v_mul_f32 v29, v68, v44
    v_mul_f32 v30, v69, v41
    v_mul_f32 v31, v69, v45
    v_mfma_f32_16x16x32_bf16 v[76:79], v[16:19], v[32:35], 0
    v_mul_f32 v120, v72, v40
    v_mul_f32 v121, v72, v44
    v_mul_f32 v122, v73, v41
    v_mfma_f32_16x16x32_bf16 v[80:83], v[20:23], v[32:35], 0
    v_mul_f32 v123, v73, v45
    v_fma_f32 v68, -v84, v44, v28
    v_fma_f32 v69, -v85, v45, v30
    v_mfma_f32_16x16x32_bf16 v[92:95], v[16:19], v[36:39], 0
    v_fma_f32 v72, -v88, v44, v120
    v_fma_f32 v73, -v89, v45, v122
    v_mfma_f32_16x16x32_bf16 v[96:99], v[20:23], v[36:39], 0
    v_fma_f32 v84, v84, v40, v29
    v_fma_f32 v85, v85, v41, v31
    v_fma_f32 v88, v88, v40, v121
    v_fma_f32 v89, v89, v41, v123
    v_mul_f32 v28, v70, v42
    v_mul_f32 v29, v70, v46
    v_mul_f32 v30, v71, v43
    v_mul_f32 v31, v71, v47
    v_mul_f32 v120, v74, v42
    v_mul_f32 v121, v74, v46
    v_mul_f32 v122, v75, v43
    v_mul_f32 v123, v75, v47
    v_fma_f32 v70, -v86, v46, v28
    v_fma_f32 v71, -v87, v47, v30
    v_fma_f32 v74, -v90, v46, v120
    v_fma_f32 v75, -v91, v47, v122
    ds_read_b64_tr_b16 v[110:111], v63 offset:4224
    v_fma_f32 v86, v86, v42, v29
    v_fma_f32 v87, v87, v43, v31
    v_fma_f32 v90, v90, v42, v121
    v_fma_f32 v91, v91, v43, v123
    v_mul_f32 v28, v76, v40
    v_mul_f32 v29, v76, v44
    v_mul_f32 v30, v77, v41
    v_mul_f32 v31, v77, v45
    v_mul_f32 v120, v80, v40
    v_mul_f32 v121, v80, v44
    v_mul_f32 v122, v81, v41
    v_mul_f32 v123, v81, v45
    v_fma_f32 v76, -v92, v44, v28
    v_fma_f32 v77, -v93, v45, v30
    v_fma_f32 v80, -v96, v44, v120
    v_fma_f32 v81, -v97, v45, v122
    ds_read_b64_tr_b16 v[112:113], v63 offset:768
    ds_read_b64_tr_b16 v[114:115], v63 offset:4480
    v_fma_f32 v92, v92, v40, v29
    v_fma_f32 v93, v93, v41, v31
    v_fma_f32 v96, v96, v40, v121
    v_fma_f32 v97, v97, v41, v123
    v_mul_f32 v28, v78, v42
    v_mul_f32 v29, v78, v46
    v_mul_f32 v30, v79, v43
    v_mul_f32 v31, v79, v47
    v_mul_f32 v120, v82, v42
    v_mul_f32 v121, v82, v46
    v_mul_f32 v122, v83, v43
    v_mul_f32 v123, v83, v47
    v_fma_f32 v78, -v94, v46, v28
    v_fma_f32 v79, -v95, v47, v30
    v_fma_f32 v82, -v98, v46, v120
    v_fma_f32 v83, -v99, v47, v122
    v_fma_f32 v94, v94, v42, v29
    v_fma_f32 v95, v95, v43, v31
    v_fma_f32 v98, v98, v42, v121
    v_fma_f32 v99, v99, v43, v123
    v_cvt_pk_bf16_f32 v8, v68, v84
    v_cvt_pk_bf16_f32 v9, v69, v85
    v_cvt_pk_bf16_f32 v10, v70, v86
    v_cvt_pk_bf16_f32 v11, v71, v87
    v_cvt_pk_bf16_f32 v12, v72, v88
    v_cvt_pk_bf16_f32 v13, v73, v89
    v_cvt_pk_bf16_f32 v14, v74, v90
    v_cvt_pk_bf16_f32 v15, v75, v91
    v_cvt_pk_bf16_f32 v16, v76, v92
    v_cvt_pk_bf16_f32 v17, v77, v93
    v_cvt_pk_bf16_f32 v18, v78, v94
    v_cvt_pk_bf16_f32 v19, v79, v95
    v_cvt_pk_bf16_f32 v20, v80, v96
    v_cvt_pk_bf16_f32 v21, v81, v97
    v_cvt_pk_bf16_f32 v22, v82, v98
    v_cvt_pk_bf16_f32 v23, v83, v99
    v_mfma_f32_16x16x32_bf16 v[68:71], v[48:51], v[8:11], 0
    s_waitcnt lgkmcnt(6)
    buffer_store_dwordx4 v[100:103], v64, s[8:11], 0 offen sc1
    s_waitcnt lgkmcnt(4)
    buffer_store_dwordx4 v[104:107], v64, s[8:11], s68 offen sc1
    v_mfma_f32_16x16x32_bf16 v[84:87], v[52:55], v[8:11], 0
    s_waitcnt lgkmcnt(2)
    buffer_store_dwordx4 v[108:111], v64, s[8:11], s69 offen sc1
    s_waitcnt lgkmcnt(0)
    buffer_store_dwordx4 v[112:115], v64, s[8:11], s70 offen sc1
    v_mfma_f32_16x16x32_bf16 v[72:75], v[48:51], v[12:15], 0
    v_mfma_f32_16x16x32_bf16 v[88:91], v[52:55], v[12:15], 0
    s_nop 1
    v_cvt_pk_bf16_f32 v8, v68, v84
    v_cvt_pk_bf16_f32 v12, v69, v85
    v_mfma_f32_16x16x32_bf16 v[76:79], v[48:51], v[16:19], 0
    v_mfma_f32_16x16x32_bf16 v[92:95], v[52:55], v[16:19], 0
    v_cvt_pk_bf16_f32 v16, v70, v86
    s_nop 0
    v_cvt_pk_bf16_f32 v9, v72, v88
    v_mfma_f32_16x16x32_bf16 v[80:83], v[48:51], v[20:23], 0
    v_cvt_pk_bf16_f32 v13, v73, v89
    v_cvt_pk_bf16_f32 v17, v74, v90
    v_mfma_f32_16x16x32_bf16 v[96:99], v[52:55], v[20:23], 0
    v_cvt_pk_bf16_f32 v20, v71, v87
    v_cvt_pk_bf16_f32 v10, v76, v92
    v_cvt_pk_bf16_f32 v14, v77, v93
    v_cvt_pk_bf16_f32 v18, v78, v94
    v_cvt_pk_bf16_f32 v21, v75, v91
    v_cvt_pk_bf16_f32 v22, v79, v95
    s_nop 1
    v_cvt_pk_bf16_f32 v11, v80, v96
    ds_write_b128 v62, v[8:11] offset:0
    v_cvt_pk_bf16_f32 v15, v81, v97
    ds_write_b128 v62, v[12:15] offset:64
    v_cvt_pk_bf16_f32 v19, v82, v98
    ds_write_b128 v62, v[16:19] offset:128
    v_cvt_pk_bf16_f32 v23, v83, v99
    ds_write_b128 v62, v[20:23] offset:192
    s_waitcnt lgkmcnt(0)
    s_barrier
    ds_read_b128 v[8:11], v65 offset:0
    ds_read_b128 v[12:15], v65 offset:4160
    ds_read_b128 v[16:19], v65 offset:8320
    s_cmp_eq_u32 s3, 3
    s_cbranch_scc1 L_row_no15
    ds_read_b128 v[20:23], v65 offset:12480
L_row_no15:
    s_mov_b32 s52, 4096
    s_mov_b32 s53, 8192
    s_mov_b32 s54, 12288
    s_waitcnt lgkmcnt(0)
    buffer_store_dwordx4 v[8:11], v66, s[8:11], 0 offen sc1
    buffer_store_dwordx4 v[12:15], v66, s[8:11], s52 offen sc1
    buffer_store_dwordx4 v[16:19], v66, s[8:11], s53 offen sc1
    s_cmp_eq_u32 s3, 3
    s_cbranch_scc1 L_row_no15s
    buffer_store_dwordx4 v[20:23], v66, s[8:11], s54 offen sc1
L_row_no15s:
    s_cmp_eq_u32 s3, 3
    s_cbranch_scc0 L_row_end
    ds_read_b128 v[68:71], v60 offset:0
    ds_read_b128 v[72:75], v61 offset:0
    ds_read_b128 v[76:79], v60 offset:64
    ds_read_b128 v[80:83], v61 offset:64
    ds_read_b128 v[84:87], v60 offset:128
    ds_read_b128 v[88:91], v61 offset:128
    ds_read_b128 v[92:95], v60 offset:192
    ds_read_b128 v[96:99], v61 offset:192
    s_waitcnt lgkmcnt(6)
    v_mfma_f32_16x16x32_bf16 v[116:119], v[68:71], v[72:75], 0
    ds_read_b128 v[68:71], v60 offset:256
    ds_read_b128 v[72:75], v61 offset:256
    s_waitcnt lgkmcnt(6)
    v_mfma_f32_16x16x32_bf16 v[116:119], v[76:79], v[80:83], v[116:119]
    ds_read_b128 v[76:79], v60 offset:320
    ds_read_b128 v[80:83], v61 offset:320
    s_waitcnt lgkmcnt(6)
    v_mfma_f32_16x16x32_bf16 v[116:119], v[84:87], v[88:91], v[116:119]
    ds_read_b128 v[84:87], v60 offset:384
    ds_read_b128 v[88:91], v61 offset:384
    s_waitcnt lgkmcnt(6)
    v_mfma_f32_16x16x32_bf16 v[116:119], v[92:95], v[96:99], v[116:119]
    ds_read_b128 v[92:95], v60 offset:448
    ds_read_b128 v[96:99], v61 offset:448
    s_waitcnt lgkmcnt(6)
    v_mfma_f32_16x16x32_bf16 v[116:119], v[68:71], v[72:75], v[116:119]
    ds_read_b128 v[68:71], v60 offset:512
    ds_read_b128 v[72:75], v61 offset:512
    s_waitcnt lgkmcnt(6)
    v_mfma_f32_16x16x32_bf16 v[116:119], v[76:79], v[80:83], v[116:119]
    ds_read_b128 v[76:79], v60 offset:576
    ds_read_b128 v[80:83], v61 offset:576
    s_waitcnt lgkmcnt(6)
    v_mfma_f32_16x16x32_bf16 v[116:119], v[84:87], v[88:91], v[116:119]
    ds_read_b128 v[84:87], v60 offset:640
    ds_read_b128 v[88:91], v61 offset:640
    s_waitcnt lgkmcnt(6)
    v_mfma_f32_16x16x32_bf16 v[116:119], v[92:95], v[96:99], v[116:119]
    ds_read_b128 v[92:95], v60 offset:704
    ds_read_b128 v[96:99], v61 offset:704
    s_waitcnt lgkmcnt(6)
    v_mfma_f32_16x16x32_bf16 v[116:119], v[68:71], v[72:75], v[116:119]
    ds_read_b128 v[68:71], v60 offset:768
    ds_read_b128 v[72:75], v61 offset:768
    s_waitcnt lgkmcnt(6)
    v_mfma_f32_16x16x32_bf16 v[116:119], v[76:79], v[80:83], v[116:119]
    ds_read_b128 v[76:79], v60 offset:832
    ds_read_b128 v[80:83], v61 offset:832
    s_waitcnt lgkmcnt(6)
    v_mfma_f32_16x16x32_bf16 v[116:119], v[84:87], v[88:91], v[116:119]
    s_waitcnt lgkmcnt(4)
    v_mfma_f32_16x16x32_bf16 v[116:119], v[92:95], v[96:99], v[116:119]
    s_waitcnt lgkmcnt(2)
    v_mfma_f32_16x16x32_bf16 v[116:119], v[68:71], v[72:75], v[116:119]
    s_waitcnt lgkmcnt(0)
    v_mfma_f32_16x16x32_bf16 v[116:119], v[76:79], v[80:83], v[116:119]
    s_nop 7
    v_cvt_pk_bf16_f32 v28, v116, v117
    v_cvt_pk_bf16_f32 v29, v118, v119
    v_lshlrev_b32 v116, 16, v28
    v_and_b32 v117, 0xffff0000, v28
    v_lshlrev_b32 v118, 16, v29
    v_and_b32 v119, 0xffff0000, v29
    v_mul_f32 v116, 0xbfb8aa3b, v116
    v_mul_f32 v117, 0xbfb8aa3b, v117
    v_mul_f32 v118, 0xbfb8aa3b, v118
    v_mul_f32 v119, 0xbfb8aa3b, v119
    v_exp_f32 v116, v116
    v_exp_f32 v117, v117
    v_exp_f32 v118, v118
    v_exp_f32 v119, v119
    v_add_f32 v116, 1.0, v116
    v_add_f32 v117, 1.0, v117
    v_add_f32 v118, 1.0, v118
    v_add_f32 v119, 1.0, v119
    v_rcp_f32 v116, v116
    v_rcp_f32 v117, v117
    v_rcp_f32 v118, v118
    v_rcp_f32 v119, v119
    v_cvt_pk_bf16_f32 v28, v116, v117
    v_cvt_pk_bf16_f32 v29, v118, v119
    v_lshlrev_b32 v116, 16, v28
    v_and_b32 v117, 0xffff0000, v28
    v_lshlrev_b32 v118, 16, v29
    v_and_b32 v119, 0xffff0000, v29
    s_lshl_b32 s50, s12, 2
    s_add_u32 s50, s50, 0x5f0000
    v_lshl_add_u32 v28, v6, 4, s50
    s_mov_b32 exec_lo, 0x00010001
    s_mov_b32 exec_hi, 0x00010001
    buffer_store_dwordx4 v[116:119], v28, s[8:11], 0 offen
L_row_end:
    s_endpgm
L_k1_w:
    v_lshrrev_b32 v1, 6, v0
    v_and_b32 v2, 63, v0
    v_readfirstlane_b32 s3, v1
    s_sub_u32 s14, s2, 576
    s_lshr_b32 s12, s14, 1
    s_and_b32 s14, s14, 1
    s_and_b32 s13, s12, 1
    v_lshrrev_b32 v3, 4, v2
    s_lshl_b32 s15, s3, 3
    v_add_u32 v3, s15, v3
    v_and_b32 v4, 15, v2
    v_lshlrev_b32 v4, 4, v4
    v_lshl_add_u32 v5, v3, 6, s12
    v_mul_u32_u24 v5, 450, v5
    s_mul_i32 s15, s14, 240
    s_lshl_b32 s48, s13, 1
    s_sub_u32 s15, s15, s48
    v_add_u32 v5, s15, v5
    v_add_u32 v5, v5, v4
    v_mul_u32_u24 v6, 288, v3
    v_add_u32 v6, v6, v4
    s_lshr_b32 s48, s3, 1
    s_lshl_b32 s48, s48, 4
    v_add_u32 v6, s48, v6
    s_mov_b32 s48, 115200
    s_waitcnt lgkmcnt(0)
    s_mov_b32 s52, s36
    s_mov_b32 s53, s37
    s_mov_b32 s54, 0xe1000
    s_mov_b32 s55, 0x20000
    s_mov_b32 s56, s38
    s_mov_b32 s57, s39
    s_mov_b32 s58, 0xe1000
    s_mov_b32 s59, 0x20000
    buffer_load_dwordx4 v[8:11], v5, s[52:55], 0 offen
    buffer_load_dwordx4 v[16:19], v5, s[56:59], 0 offen
    buffer_load_dwordx4 v[12:15], v5, s[52:55], s48 offen
    buffer_load_dwordx4 v[20:23], v5, s[56:59], s48 offen
    s_add_u32 s8, s46, 0x800000
    s_addc_u32 s9, s47, 0
    s_mov_b32 s10, 0x1c4000
    s_mov_b32 s11, 0x20000
    s_mov_b32 s67, 224
    v_lshrrev_b32 v41, 4, v2
    v_bfe_u32 v42, v2, 2, 2
    v_lshl_add_u32 v42, v41, 2, v42
    v_bfe_u32 v43, v2, 1, 1
    v_lshl_add_u32 v42, v43, 4, v42
    v_mul_u32_u24 v42, 288, v42
    v_lshl_add_u32 v42, v43, 4, v42
    v_and_b32 v43, 1, v2
    v_lshl_add_u32 v42, v43, 3, v42
    s_lshl_b32 s63, s3, 4
    v_add_u32 v42, s63, v42
    v_and_b32 v40, 15, v2
    s_mul_i32 s63, s14, 120
    s_lshl_b32 s62, s3, 3
    s_add_u32 s63, s63, s62
    s_sub_u32 s63, s63, s13
    v_and_b32 v43, 7, v40
    v_add_u32 v43, s63, v43
    s_mul_i32 s63, s12, 28928
    v_lshl_add_u32 v45, v41, 4, s63
    v_lshrrev_b32 v46, 3, v40
    v_lshl_add_u32 v45, v46, 6, v45
    v_lshl_add_u32 v44, v43, 7, v45
    v_mov_b32 v47, 0x7ffffff0
    s_sub_u32 s62, 119, s13
    s_cmp_eq_u32 s14, 0
    s_cselect_b32 s66, s62, s67
    s_mov_b32 s64, 0x05040100
    s_mov_b32 s65, 0x07060302
    s_waitcnt vmcnt(0)
    ds_write_b128 v6, v[8:11] offset:0
    ds_write_b128 v6, v[16:19] offset:9216
    ds_write_b128 v6, v[12:15] offset:1152
    ds_write_b128 v6, v[20:23] offset:10368
    s_waitcnt lgkmcnt(0)
    s_barrier
    ds_read_b64_tr_b16 v[8:9], v42 offset:0
    ds_read_b64_tr_b16 v[10:11], v42 offset:9216
    ds_read_b64_tr_b16 v[12:13], v42 offset:64
    ds_read_b64_tr_b16 v[14:15], v42 offset:9280
    ds_read_b64_tr_b16 v[16:17], v42 offset:128
    ds_read_b64_tr_b16 v[18:19], v42 offset:9344
    ds_read_b64_tr_b16 v[20:21], v42 offset:192
    ds_read_b64_tr_b16 v[22:23], v42 offset:9408
    v_add_u32 v108, 0, v43
    v_cmp_le_u32 s[60:61], v108, s66
    v_add_u32 v104, 0, v44
    s_nop 0
    v_cndmask_b32 v104, v47, v104, s[60:61]
    v_add_u32 v109, 32, v43
    v_cmp_le_u32 s[62:63], v109, s66
    v_add_u32 v105, 4096, v44
    s_nop 0
    v_cndmask_b32 v105, v47, v105, s[62:63]
    v_add_u32 v108, 64, v43
    v_cmp_le_u32 s[60:61], v108, s66
    v_add_u32 v106, 8192, v44
    s_nop 0
    v_cndmask_b32 v106, v47, v106, s[60:61]
    v_add_u32 v109, 96, v43
    v_cmp_le_u32 s[62:63], v109, s66
    v_add_u32 v107, 12288, v44
    s_nop 0
    v_cndmask_b32 v107, v47, v107, s[62:63]
    s_waitcnt lgkmcnt(6)
    v_perm_b32 v88, v10, v8, s64
    v_perm_b32 v89, v10, v8, s65
    v_perm_b32 v90, v11, v9, s64
    v_perm_b32 v91, v11, v9, s65
    buffer_store_dwordx4 v[88:91], v104, s[8:11], 0 offen sc1
    s_waitcnt lgkmcnt(4)
    v_perm_b32 v92, v14, v12, s64
    v_perm_b32 v93, v14, v12, s65
    v_perm_b32 v94, v15, v13, s64
    v_perm_b32 v95, v15, v13, s65
    buffer_store_dwordx4 v[92:95], v105, s[8:11], 0 offen sc1
    s_waitcnt lgkmcnt(2)
    v_perm_b32 v96, v18, v16, s64
    v_perm_b32 v97, v18, v16, s65
    v_perm_b32 v98, v19, v17, s64
    v_perm_b32 v99, v19, v17, s65
    buffer_store_dwordx4 v[96:99], v106, s[8:11], 0 offen sc1
    s_waitcnt lgkmcnt(0)
    v_perm_b32 v100, v22, v20, s64
    v_perm_b32 v101, v22, v20, s65
    v_perm_b32 v102, v23, v21, s64
    v_perm_b32 v103, v23, v21, s65
    buffer_store_dwordx4 v[100:103], v107, s[8:11], 0 offen sc1
    s_endpgm
.globl ssm_mix_kernel
.p2align 8
.type ssm_mix_kernel,@function
ssm_mix_kernel:
    s_load_dwordx16 s[16:31], s[0:1], 0
    s_load_dwordx16 s[32:47], s[0:1], 64
    s_cmp_lt_u32 s2, 225
    s_cbranch_scc1 L_k2_col
    s_cmp_lt_u32 s2, 449
    s_cbranch_scc1 L_k2_conv
    s_endpgm
L_k2_conv:
    v_lshrrev_b32 v1, 6, v0
    v_and_b32 v2, 63, v0
    v_readfirstlane_b32 s3, v1
    s_sub_u32 s2, s2, 225
    s_and_b32 s48, s2, 7
    s_lshl_b32 s48, s48, 1
    s_bfe_u32 s49, s2, 0x10003
    s_add_u32 s48, s48, s49
    s_and_b32 s49, s2, 0xf0
    s_add_u32 s48, s48, s49
    s_lshl_b32 s15, s48, 2
    s_lshr_b32 s12, s3, 1
    s_and_b32 s13, s3, 1
    s_lshl_b32 s14, s48, 1
    s_add_u32 s14, s14, s12
    s_lshl_b32 s48, s13, 6
    v_add_u32 v3, s48, v2
    s_mul_i32 s49, s14, 2048
    s_add_u32 s49, s49, 0x600000
    v_lshl_add_u32 v4, v3, 4, s49
    s_lshl_b32 s50, s15, 4
    s_add_u32 s50, s50, 0x300000
    v_lshrrev_b32 v5, 2, v0
    v_mul_u32_u24 v5, 14592, v5
    v_and_b32 v6, 3, v0
    v_lshl_add_u32 v5, v6, 4, v5
    v_add_u32 v5, s50, v5
    s_mov_b32 s50, 933888
    s_waitcnt lgkmcnt(0)
    s_mov_b32 s8, s46
    s_mov_b32 s9, s47
    s_mov_b32 s10, 0x1200000
    s_mov_b32 s11, 0x20000
    s_load_dword s51, s[32:33], s15
    s_mov_b32 s66, 4096
    buffer_load_dwordx4 v[16:19], v4, s[8:11], 0 offen offset:0
    buffer_load_dwordx4 v[20:23], v4, s[8:11], 0 offen offset:4
    buffer_load_dwordx4 v[24:27], v4, s[8:11], 0 offen offset:8
    buffer_load_dwordx4 v[40:43], v5, s[8:11], 0 offen
    buffer_load_dwordx4 v[44:47], v5, s[8:11], s50 offen
    s_mul_i32 s52, s12, 13696
    s_add_u32 s52, s52, 128
    s_add_u32 s53, s52, 8448
    s_mov_b32 s67, 9664
    v_lshl_add_u32 v6, v3, 4, s52
    v_lshl_add_u32 v7, v3, 4, s53
    v_lshrrev_b32 v8, 2, v0
    v_lshlrev_b32 v8, 5, v8
    v_and_b32 v9, 1, v0
    v_lshl_add_u32 v8, v9, 4, v8
    v_bfe_u32 v9, v0, 1, 1
    v_mul_u32_u24 v9, 13696, v9
    v_add3_u32 v8, v8, v9, s67
    v_mov_b32 v32, 0
    v_mov_b32 v33, 0
    v_mov_b32 v34, 0
    v_mov_b32 v35, 0
    v_cmp_gt_u32 vcc, 68, v3
    s_nop 3
    s_and_saveexec_b64 s[60:61], vcc
    ds_write_b128 v7, v[32:35]
    v_cmp_gt_u32 vcc, 4, v3
    s_nop 3
    s_and_b64 exec, exec, vcc
    s_cbranch_execz L_cv_nopad
    ds_write_b128 v7, v[32:35] offset:5184
L_cv_nopad:
    s_mov_b64 exec, s[60:61]
    v_and_b32 v48, 15, v2
    v_lshrrev_b32 v49, 4, v2
    v_and_b32 v50, 3, v48
    v_lshrrev_b32 v51, 2, v48
    v_mul_u32_u24 v50, 2112, v50
    v_lshlrev_b32 v51, 3, v51
    v_sub_u32 v50, v50, v51
    v_add_u32 v50, s52, v50
    v_lshl_add_u32 v10, v49, 4, v50
    v_lshl_add_u32 v11, v49, 3, v50
    v_lshlrev_b32 v51, 5, v48
    v_add_u32 v51, s53, v51
    v_lshl_add_u32 v12, v49, 4, v51
    v_lshl_add_u32 v13, v49, 3, v51
    v_lshlrev_b32 v14, 5, v48
    v_lshrrev_b32 v53, 1, v49
    v_lshl_add_u32 v14, v53, 4, v14
    v_and_b32 v53, 1, v49
    v_lshl_add_u32 v14, v53, 9, v14
    s_mul_i32 s59, s14, 4352
    s_add_u32 s59, s59, 0xe00000
    v_add_u32 v14, s59, v14
    v_lshlrev_b32 v52, 3, v49
    v_sub_u32 v52, v52, v48
    s_mov_b32 s55, 0x10001
    v_add_u32 v53, 9, v52
    v_med3_i32 v53, v53, 0, 31
    s_mov_b32 s56, 0x700000
    v_lshrrev_b32_e64 v53, v53, s56
    v_bfe_u32 v54, v53, 0, 2
    v_mul_u32_u24 v54, 0x8001, v54
    v_and_b32 v54, s55, v54
    v_mul_u32_u24 v120, 0x3f80, v54
    v_bfe_u32 v54, v53, 2, 2
    v_mul_u32_u24 v54, 0x8001, v54
    v_and_b32 v54, s55, v54
    v_mul_u32_u24 v121, 0x3f80, v54
    v_bfe_u32 v54, v53, 4, 2
    v_mul_u32_u24 v54, 0x8001, v54
    v_and_b32 v54, s55, v54
    v_mul_u32_u24 v122, 0x3f80, v54
    v_bfe_u32 v54, v53, 6, 2
    v_mul_u32_u24 v54, 0x8001, v54
    v_and_b32 v54, s55, v54
    v_mul_u32_u24 v123, 0x3f80, v54
    v_add_u32 v53, 14, v52
    v_med3_i32 v53, v53, 0, 31
    s_mov_b32 s56, 0x1f00000
    v_lshrrev_b32_e64 v53, v53, s56
    v_bfe_u32 v54, v53, 0, 2
    v_mul_u32_u24 v54, 0x8001, v54
    v_and_b32 v54, s55, v54
    v_mul_u32_u24 v124, 0x3f80, v54
    v_bfe_u32 v54, v53, 2, 2
    v_mul_u32_u24 v54, 0x8001, v54
    v_and_b32 v54, s55, v54
    v_mul_u32_u24 v125, 0x3f80, v54
    v_bfe_u32 v54, v53, 4, 2
    v_mul_u32_u24 v54, 0x8001, v54
    v_and_b32 v54, s55, v54
    v_mul_u32_u24 v126, 0x3f80, v54
    v_bfe_u32 v54, v53, 6, 2
    v_mul_u32_u24 v54, 0x8001, v54
    v_and_b32 v54, s55, v54
    v_mul_u32_u24 v127, 0x3f80, v54
    v_add_u32 v53, 17, v52
    v_med3_i32 v53, v53, 0, 31
    s_mov_b32 s56, 0x700000
    v_lshrrev_b32_e64 v53, v53, s56
    v_bfe_u32 v54, v53, 0, 2
    v_mul_u32_u24 v54, 0x8001, v54
    v_and_b32 v54, s55, v54
    v_mul_u32_u24 v128, 0x3f80, v54
    v_bfe_u32 v54, v53, 2, 2
    v_mul_u32_u24 v54, 0x8001, v54
    v_and_b32 v54, s55, v54
    v_mul_u32_u24 v129, 0x3f80, v54
    v_bfe_u32 v54, v53, 4, 2
    v_mul_u32_u24 v54, 0x8001, v54
    v_and_b32 v54, s55, v54
    v_mul_u32_u24 v130, 0x3f80, v54
    v_bfe_u32 v54, v53, 6, 2
    v_mul_u32_u24 v54, 0x8001, v54
    v_and_b32 v54, s55, v54
    v_mul_u32_u24 v131, 0x3f80, v54
    v_add_u32 v53, 15, v52
    v_med3_i32 v53, v53, 0, 31
    s_mov_b32 s56, 0x7f00000
    v_lshrrev_b32_e64 v53, v53, s56
    v_bfe_u32 v54, v53, 0, 2
    v_mul_u32_u24 v54, 0x8001, v54
    v_and_b32 v54, s55, v54
    v_mul_u32_u24 v132, 0x3f80, v54
    v_bfe_u32 v54, v53, 2, 2
    v_mul_u32_u24 v54, 0x8001, v54
    v_and_b32 v54, s55, v54
    v_mul_u32_u24 v133, 0x3f80, v54
    v_bfe_u32 v54, v53, 4, 2
    v_mul_u32_u24 v54, 0x8001, v54
    v_and_b32 v54, s55, v54
    v_mul_u32_u24 v134, 0x3f80, v54
    v_bfe_u32 v54, v53, 6, 2
    v_mul_u32_u24 v54, 0x8001, v54
    v_and_b32 v54, s55, v54
    v_mul_u32_u24 v135, 0x3f80, v54
    v_add_u32 v53, 16, v52
    v_med3_i32 v53, v53, 0, 31
    s_mov_b32 s56, 0x1ff00000
    v_lshrrev_b32_e64 v53, v53, s56
    v_bfe_u32 v54, v53, 0, 2
    v_mul_u32_u24 v54, 0x8001, v54
    v_and_b32 v54, s55, v54
    v_mul_u32_u24 v136, 0x3f80, v54
    v_bfe_u32 v54, v53, 2, 2
    v_mul_u32_u24 v54, 0x8001, v54
    v_and_b32 v54, s55, v54
    v_mul_u32_u24 v137, 0x3f80, v54
    v_bfe_u32 v54, v53, 4, 2
    v_mul_u32_u24 v54, 0x8001, v54
    v_and_b32 v54, s55, v54
    v_mul_u32_u24 v138, 0x3f80, v54
    v_bfe_u32 v54, v53, 6, 2
    v_mul_u32_u24 v54, 0x8001, v54
    v_and_b32 v54, s55, v54
    v_mul_u32_u24 v139, 0x3f80, v54
    v_add_u32 v53, 8, v52
    v_med3_i32 v53, v53, 0, 31
    s_mov_b32 s56, 0x300000
    v_lshrrev_b32_e64 v53, v53, s56
    v_bfe_u32 v54, v53, 0, 2
    v_mul_u32_u24 v54, 0x8001, v54
    v_and_b32 v54, s55, v54
    v_mul_u32_u24 v140, 0xffff, v54
    v_bfe_u32 v54, v53, 2, 2
    v_mul_u32_u24 v54, 0x8001, v54
    v_and_b32 v54, s55, v54
    v_mul_u32_u24 v141, 0xffff, v54
    v_bfe_u32 v54, v53, 4, 2
    v_mul_u32_u24 v54, 0x8001, v54
    v_and_b32 v54, s55, v54
    v_mul_u32_u24 v142, 0xffff, v54
    v_bfe_u32 v54, v53, 6, 2
    v_mul_u32_u24 v54, 0x8001, v54
    v_and_b32 v54, s55, v54
    v_mul_u32_u24 v143, 0xffff, v54
    s_waitcnt vmcnt(2)
    ds_write_b128 v6, v[16:19] offset:6336
    ds_write_b128 v6, v[20:23] offset:2112
    v_alignbit_b32 v28, v20, v16, 16
    v_alignbit_b32 v29, v21, v17, 16
    v_alignbit_b32 v30, v22, v18, 16
    v_alignbit_b32 v31, v23, v19, 16
    v_alignbit_b32 v36, v24, v20, 16
    v_alignbit_b32 v37, v25, v21, 16
    v_alignbit_b32 v38, v26, v22, 16
    v_alignbit_b32 v39, v27, v23, 16
    ds_write_b128 v6, v[28:31] offset:4224
    ds_write_b128 v6, v[36:39] offset:0
    s_waitcnt vmcnt(0)
    ds_write_b128 v8, v[40:43]
    ds_write_b128 v8, v[44:47] offset:2048
    s_lshl_b32 s58, s12, 4
    v_mov_b32 v53, s52
    s_waitcnt lgkmcnt(0)
    s_lshr_b32 s51, s51, s58
    s_lshl_b32 s56, s51, 16
    s_mov_b32 s57, s56
    s_barrier
    s_waitcnt vmcnt(0)
    ds_read_u16 v54, v53 offset:7840
    s_waitcnt lgkmcnt(0)
    v_lshl_or_b32 v54, v54, 16, v54
    v_and_b32 v160, v54, v140
    v_and_b32 v161, v54, v141
    v_and_b32 v162, v54, v142
    v_and_b32 v163, v54, v143
    s_cmp_eq_u32 s13, 0
    s_cbranch_scc0 L_cv_h1
    ds_read_b64 v[32:33], v10 offset:1112
    ds_read_b64 v[34:35], v10 offset:1120
    ds_read_b128 v[104:107], v12 offset:1600
    ds_read_b64 v[36:37], v10 offset:1048
    ds_read_b64 v[38:39], v10 offset:1056
    ds_read_b128 v[108:111], v12 offset:1536
    ds_read_b64 v[40:41], v10 offset:984
    ds_read_b64 v[42:43], v10 offset:992
    ds_read_b128 v[112:115], v12 offset:1472
    ds_read_b64 v[44:45], v10 offset:920
    ds_read_b64 v[46:47], v10 offset:928
    ds_read_b128 v[116:119], v12 offset:1408
    ds_read_b64 v[48:49], v10 offset:856
    ds_read_b64 v[50:51], v10 offset:864
    s_waitcnt lgkmcnt(11)
    v_mfma_f32_16x16x32_bf16 v[20:23], v[32:35], v[104:107], 0
    ds_read_b128 v[104:107], v12 offset:1344
    ds_read_b64 v[52:53], v10 offset:792
    ds_read_b64 v[54:55], v10 offset:800
    s_waitcnt lgkmcnt(11)
    v_mfma_f32_16x16x32_bf16 v[20:23], v[36:39], v[108:111], v[20:23]
    ds_read_b128 v[108:111], v12 offset:1280
    ds_read_b64 v[56:57], v10 offset:728
    s_waitcnt lgkmcnt(10)
    v_mfma_f32_16x16x32_bf16 v[20:23], v[40:43], v[112:115], v[20:23]
    ds_read_b64 v[58:59], v10 offset:736
    ds_read_b128 v[112:115], v12 offset:1216
    ds_read_b64 v[60:61], v10 offset:664
    s_waitcnt lgkmcnt(10)
    v_mfma_f32_16x16x32_bf16 v[20:23], v[44:47], v[116:119], v[20:23]
    ds_read_b64 v[62:63], v10 offset:672
    ds_read_b128 v[116:119], v12 offset:1152
    ds_read_b64 v[64:65], v10 offset:600
    ds_read_b64 v[66:67], v10 offset:608
    s_waitcnt lgkmcnt(11)
    v_mfma_f32_16x16x32_bf16 v[20:23], v[48:51], v[104:107], v[20:23]
    ds_read_b128 v[104:107], v12 offset:1088
    ds_read_b64 v[68:69], v10 offset:536
    ds_read_b64 v[70:71], v10 offset:544
    s_waitcnt lgkmcnt(11)
    v_mfma_f32_16x16x32_bf16 v[20:23], v[52:55], v[108:111], v[20:23]
    ds_read_b128 v[108:111], v12 offset:1024
    ds_read_b64 v[72:73], v10 offset:472
    ds_read_b64 v[74:75], v10 offset:480
    s_waitcnt lgkmcnt(11)
    v_mfma_f32_16x16x32_bf16 v[20:23], v[56:59], v[112:115], v[20:23]
    ds_read_b128 v[112:115], v12 offset:960
    ds_read_b64 v[76:77], v10 offset:408
    ds_read_b64 v[78:79], v10 offset:416
    s_waitcnt lgkmcnt(11)
    v_mfma_f32_16x16x32_bf16 v[20:23], v[60:63], v[116:119], v[20:23]
    ds_read_b128 v[116:119], v12 offset:896
    ds_read_b64 v[80:81], v10 offset:344
    ds_read_b64 v[82:83], v10 offset:352
    s_waitcnt lgkmcnt(11)
    v_mfma_f32_16x16x32_bf16 v[16:19], v[32:35], v[104:107], 0
    ds_read_b64 v[84:85], v10 offset:280
    ds_read_b64 v[86:87], v10 offset:288
    v_mfma_f32_16x16x32_bf16 v[20:23], v[64:67], v[104:107], v[20:23]
    ds_read_b128 v[104:107], v12 offset:832
    s_waitcnt lgkmcnt(11)
    v_mfma_f32_16x16x32_bf16 v[16:19], v[36:39], v[108:111], v[16:19]
    ds_read_b64 v[88:89], v10 offset:216
    ds_read_b64 v[90:91], v10 offset:224
    v_mfma_f32_16x16x32_bf16 v[20:23], v[68:71], v[108:111], v[20:23]
    ds_read_b128 v[108:111], v12 offset:768
    s_waitcnt lgkmcnt(11)
    v_mfma_f32_16x16x32_bf16 v[16:19], v[40:43], v[112:115], v[16:19]
    ds_read_b64 v[92:93], v10 offset:152
    ds_read_b64 v[94:95], v10 offset:160
    v_mfma_f32_16x16x32_bf16 v[20:23], v[72:75], v[112:115], v[20:23]
    ds_read_b128 v[112:115], v12 offset:704
    s_waitcnt lgkmcnt(11)
    v_mfma_f32_16x16x32_bf16 v[16:19], v[44:47], v[116:119], v[16:19]
    ds_read_b64 v[96:97], v10 offset:88
    ds_read_b64 v[98:99], v10 offset:96
    v_mfma_f32_16x16x32_bf16 v[20:23], v[76:79], v[116:119], v[20:23]
    ds_read_b128 v[116:119], v12 offset:640
    s_waitcnt lgkmcnt(9)
    v_mfma_f32_16x16x32_bf16 v[16:19], v[48:51], v[104:107], v[16:19]
    ds_read_b64 v[2:3], v13 offset:1088
    ds_read_b64 v[4:5], v13 offset:1600
    v_mfma_f32_16x16x32_bf16 v[20:23], v[80:83], v[104:107], v[20:23]
    ds_read_b128 v[104:107], v12 offset:576
    ds_read_b64 v[100:101], v10 offset:24
    s_waitcnt lgkmcnt(10)
    v_mfma_f32_16x16x32_bf16 v[16:19], v[52:55], v[108:111], v[16:19]
    ds_read_b64 v[102:103], v10 offset:32
    ds_read_b64 v[144:145], v11 offset:1656
    v_mfma_f32_16x16x32_bf16 v[20:23], v[84:87], v[108:111], v[20:23]
    ds_read_b128 v[108:111], v12 offset:4672
    s_waitcnt lgkmcnt(10)
    v_mfma_f32_16x16x32_bf16 v[16:19], v[56:59], v[112:115], v[16:19]
    ds_read_b64 v[146:147], v11 offset:1816
    ds_read_b64 v[148:149], v11 offset:1624
    v_mfma_f32_16x16x32_bf16 v[20:23], v[88:91], v[112:115], v[20:23]
    ds_read_b128 v[112:115], v12 offset:4608
    s_waitcnt lgkmcnt(10)
    v_mfma_f32_16x16x32_bf16 v[16:19], v[60:63], v[116:119], v[16:19]
    ds_read_b64 v[150:151], v11 offset:1784
    ds_read_b64 v[152:153], v11 offset:1688
    v_mfma_f32_16x16x32_bf16 v[20:23], v[92:95], v[116:119], v[20:23]
    s_waitcnt lgkmcnt(11)
    v_lshlrev_b32 v164, 16, v2
    v_and_b32 v165, 0xffff0000, v2
    v_lshlrev_b32 v166, 16, v3
    s_waitcnt lgkmcnt(9)
    v_mfma_f32_16x16x32_bf16 v[16:19], v[64:67], v[104:107], v[16:19]
    v_and_b32 v167, 0xffff0000, v3
    ds_read_b128 v[116:119], v12 offset:4544
    v_mfma_f32_16x16x32_bf16 v[20:23], v[96:99], v[104:107], v[20:23]
    ds_read_b128 v[104:107], v12 offset:4480
    ds_read_b64 v[154:155], v11 offset:1848
    s_waitcnt lgkmcnt(8)
    v_mfma_f32_16x16x32_bf16 v[28:31], v[32:35], v[108:111], 0
    ds_read_b128 v[108:111], v12 offset:4416
    v_fmac_f32 v16, s56, v164
    v_fmac_f32 v17, s56, v165
    v_fmac_f32 v18, s56, v166
    v_fmac_f32 v19, s56, v167
    v_lshlrev_b32 v164, 16, v4
    v_and_b32 v165, 0xffff0000, v4
    v_lshlrev_b32 v166, 16, v5
    v_and_b32 v167, 0xffff0000, v5
    v_fmac_f32 v20, s56, v164
    v_fmac_f32 v21, s56, v165
    v_fmac_f32 v22, s56, v166
    v_fmac_f32 v23, s56, v167
    v_cvt_pk_bf16_f32 v6, v16, v17
    v_cvt_pk_bf16_f32 v7, v18, v19
    v_cvt_pk_bf16_f32 v8, v20, v21
    v_cvt_pk_bf16_f32 v9, v22, v23
    s_nop 0
    v_permlane16_swap_b32 v6, v8
    v_permlane16_swap_b32 v7, v9
    buffer_store_dwordx4 v[6:9], v14, s[8:11], 0 offen offset:0 sc1
    s_waitcnt lgkmcnt(6)
    v_mfma_f32_16x16x32_bf16 v[28:31], v[36:39], v[112:115], v[28:31]
    ds_read_b128 v[112:115], v12 offset:4352
    ds_read_b64 v[156:157], v11 offset:1656
    s_waitcnt lgkmcnt(5)
    v_mfma_f32_16x16x32_bf16 v[28:31], v[40:43], v[116:119], v[28:31]
    ds_read_b128 v[116:119], v12 offset:4288
    s_waitcnt lgkmcnt(5)
    v_mfma_f32_16x16x32_bf16 v[28:31], v[44:47], v[104:107], v[28:31]
    ds_read_b128 v[104:107], v12 offset:4224
    s_waitcnt lgkmcnt(4)
    v_mfma_f32_16x16x32_bf16 v[28:31], v[48:51], v[108:111], v[28:31]
    ds_read_b128 v[108:111], v12 offset:4160
    ds_read_b64 v[158:159], v11 offset:1816
    ds_read_b64 v[2:3], v13 offset:4160
    ds_read_b64 v[4:5], v13 offset:4672
    s_waitcnt lgkmcnt(7)
    v_mfma_f32_16x16x32_bf16 v[28:31], v[52:55], v[112:115], v[28:31]
    ds_read_b128 v[112:115], v12 offset:4096
    s_waitcnt lgkmcnt(6)
    v_mfma_f32_16x16x32_bf16 v[28:31], v[56:59], v[116:119], v[28:31]
    ds_read_b128 v[116:119], v12 offset:4032
    s_waitcnt lgkmcnt(6)
    v_mfma_f32_16x16x32_bf16 v[28:31], v[60:63], v[104:107], v[28:31]
    ds_read_b128 v[104:107], v12 offset:3968
    s_waitcnt lgkmcnt(6)
    v_mfma_f32_16x16x32_bf16 v[24:27], v[32:35], v[108:111], 0
    ds_read_b128 v[32:35], v12 offset:1056
    v_mfma_f32_16x16x32_bf16 v[28:31], v[64:67], v[108:111], v[28:31]
    ds_read_b128 v[108:111], v12 offset:3904
    s_waitcnt lgkmcnt(6)
    v_lshlrev_b32 v164, 16, v2
    v_and_b32 v165, 0xffff0000, v2
    v_lshlrev_b32 v166, 16, v3
    v_and_b32 v167, 0xffff0000, v3
    s_waitcnt lgkmcnt(4)
    v_mfma_f32_16x16x32_bf16 v[24:27], v[36:39], v[112:115], v[24:27]
    ds_read_b128 v[36:39], v12 offset:1040
    v_mfma_f32_16x16x32_bf16 v[28:31], v[68:71], v[112:115], v[28:31]
    ds_read_b128 v[112:115], v12 offset:3840
    s_waitcnt lgkmcnt(5)
    v_mfma_f32_16x16x32_bf16 v[24:27], v[40:43], v[116:119], v[24:27]
    ds_read_b128 v[40:43], v12 offset:1568
    v_mfma_f32_16x16x32_bf16 v[28:31], v[72:75], v[116:119], v[28:31]
    ds_read_b128 v[116:119], v12 offset:3776
    s_waitcnt lgkmcnt(6)
    v_mfma_f32_16x16x32_bf16 v[24:27], v[44:47], v[104:107], v[24:27]
    ds_read_b128 v[44:47], v12 offset:1552
    v_mfma_f32_16x16x32_bf16 v[28:31], v[76:79], v[104:107], v[28:31]
    ds_read_b128 v[104:107], v12 offset:3712
    s_waitcnt lgkmcnt(6)
    v_mfma_f32_16x16x32_bf16 v[24:27], v[48:51], v[108:111], v[24:27]
    v_mfma_f32_16x16x32_bf16 v[28:31], v[80:83], v[108:111], v[28:31]
    ds_read_b128 v[108:111], v12 offset:3648
    s_waitcnt lgkmcnt(5)
    v_mfma_f32_16x16x32_bf16 v[24:27], v[52:55], v[112:115], v[24:27]
    v_mfma_f32_16x16x32_bf16 v[28:31], v[84:87], v[112:115], v[28:31]
    ds_read_b128 v[112:115], v12 offset:3584
    s_waitcnt lgkmcnt(4)
    v_mfma_f32_16x16x32_bf16 v[24:27], v[56:59], v[116:119], v[24:27]
    v_mfma_f32_16x16x32_bf16 v[28:31], v[88:91], v[116:119], v[28:31]
    ds_read_b128 v[116:119], v12 offset:3520
    s_waitcnt lgkmcnt(3)
    v_mfma_f32_16x16x32_bf16 v[24:27], v[60:63], v[104:107], v[24:27]
    v_mfma_f32_16x16x32_bf16 v[28:31], v[92:95], v[104:107], v[28:31]
    ds_read_b128 v[104:107], v12 offset:3456
    s_waitcnt lgkmcnt(3)
    v_mfma_f32_16x16x32_bf16 v[24:27], v[64:67], v[108:111], v[24:27]
    v_mfma_f32_16x16x32_bf16 v[28:31], v[96:99], v[108:111], v[28:31]
    ds_read_b128 v[108:111], v12 offset:3392
    v_mfma_f32_16x16x32_bf16 v[64:67], v[32:35], v[132:135], 0
    ds_read_b128 v[32:35], v12 offset:2080
    s_waitcnt lgkmcnt(4)
    v_mfma_f32_16x16x32_bf16 v[24:27], v[68:71], v[112:115], v[24:27]
    v_mfma_f32_16x16x32_bf16 v[28:31], v[100:103], v[112:115], v[28:31]
    ds_read_b128 v[112:115], v12 offset:3328
    s_waitcnt lgkmcnt(4)
    v_mfma_f32_16x16x32_bf16 v[24:27], v[72:75], v[116:119], v[24:27]
    ds_read_b128 v[116:119], v12 offset:3264
    v_mfma_f32_16x16x32_bf16 v[68:71], v[36:39], v[136:139], 0
    ds_read_b128 v[36:39], v12 offset:2064
    s_waitcnt lgkmcnt(5)
    v_mfma_f32_16x16x32_bf16 v[24:27], v[76:79], v[104:107], v[24:27]
    ds_read_b128 v[104:107], v12 offset:3200
    s_waitcnt lgkmcnt(5)
    v_mfma_f32_16x16x32_bf16 v[24:27], v[80:83], v[108:111], v[24:27]
    ds_read_b128 v[108:111], v12 offset:3136
    s_waitcnt lgkmcnt(5)
    v_mfma_f32_16x16x32_bf16 v[48:51], v[32:35], v[120:123], 0
    v_mfma_f32_16x16x32_bf16 v[52:55], v[32:35], v[124:127], 0
    v_mfma_f32_16x16x32_bf16 v[56:59], v[32:35], v[128:131], 0
    s_waitcnt lgkmcnt(4)
    v_mfma_f32_16x16x32_bf16 v[24:27], v[84:87], v[112:115], v[24:27]
    ds_read_b128 v[112:115], v12 offset:3072
    s_waitcnt lgkmcnt(4)
    v_mfma_f32_16x16x32_bf16 v[24:27], v[88:91], v[116:119], v[24:27]
    v_mfma_f32_16x16x32_bf16 v[88:91], v[40:43], v[132:135], 0
    ds_read_b128 v[40:43], v12 offset:2592
    s_waitcnt lgkmcnt(3)
    v_mfma_f32_16x16x32_bf16 v[24:27], v[92:95], v[104:107], v[24:27]
    v_cvt_pk_bf16_f32 v104, v64, v65
    v_cvt_pk_bf16_f32 v105, v66, v67
    v_cvt_pk_bf16_f32 v106, v68, v69
    v_mfma_f32_16x16x32_bf16 v[92:95], v[44:47], v[136:139], 0
    v_cvt_pk_bf16_f32 v107, v70, v71
    v_cvt_pk_bf16_f32 v116, v88, v89
    s_waitcnt lgkmcnt(2)
    v_mfma_f32_16x16x32_bf16 v[24:27], v[96:99], v[108:111], v[24:27]
    v_cvt_pk_bf16_f32 v117, v90, v91
    ds_read_b128 v[44:47], v12 offset:2576
    v_mfma_f32_16x16x32_bf16 v[28:31], v[104:107], v[148:151], v[28:31]
    ds_read_b64 v[148:149], v11 offset:1400
    v_cvt_pk_bf16_f32 v118, v92, v93
    v_cvt_pk_bf16_f32 v119, v94, v95
    ds_read_b64 v[150:151], v11 offset:1496
    v_mfma_f32_16x16x32_bf16 v[60:63], v[36:39], v[124:127], 0
    v_cvt_pk_bf16_f32 v96, v48, v49
    v_cvt_pk_bf16_f32 v97, v50, v51
    s_waitcnt lgkmcnt(4)
    v_mfma_f32_16x16x32_bf16 v[24:27], v[100:103], v[112:115], v[24:27]
    v_cvt_pk_bf16_f32 v98, v52, v53
    v_cvt_pk_bf16_f32 v99, v54, v55
    v_mfma_f32_16x16x32_bf16 v[24:27], v[104:107], v[144:147], v[24:27]
    ds_read_b64 v[144:145], v11 offset:1208
    ds_read_b64 v[146:147], v11 offset:1304
    v_mfma_f32_16x16x32_bf16 v[24:27], v[116:119], v[152:155], v[24:27]
    ds_read_b64 v[152:153], v11 offset:1720
    ds_read_b64 v[154:155], v11 offset:1880
    v_mfma_f32_16x16x32_bf16 v[64:67], v[32:35], v[132:135], 0
    v_cvt_pk_bf16_f32 v100, v56, v57
    v_cvt_pk_bf16_f32 v101, v58, v59
    v_mfma_f32_16x16x32_bf16 v[68:71], v[36:39], v[136:139], 0
    v_cvt_pk_bf16_f32 v102, v60, v61
    v_cvt_pk_bf16_f32 v103, v62, v63
    v_mfma_f32_16x16x32_bf16 v[28:31], v[116:119], v[156:159], v[28:31]
    ds_read_b64 v[156:157], v11 offset:1688
    ds_read_b64 v[158:159], v11 offset:1848
    v_mfma_f32_16x16x32_bf16 v[24:27], v[160:163], v[32:35], v[24:27]
    v_cvt_pk_bf16_f32 v104, v64, v65
    v_cvt_pk_bf16_f32 v105, v66, v67
    v_cvt_pk_bf16_f32 v106, v68, v69
    v_cvt_pk_bf16_f32 v107, v70, v71
    s_waitcnt lgkmcnt(9)
    v_mfma_f32_16x16x32_bf16 v[72:75], v[40:43], v[120:123], 0
    ds_read_b128 v[32:35], v12 offset:3104
    ds_read_b128 v[36:39], v12 offset:3088
    s_waitcnt lgkmcnt(6)
    v_mfma_f32_16x16x32_bf16 v[24:27], v[96:99], v[144:147], v[24:27]
    ds_read_b64 v[144:145], v11 offset:1240
    ds_read_b64 v[146:147], v11 offset:1336
    v_mfma_f32_16x16x32_bf16 v[24:27], v[100:103], v[148:151], v[24:27]
    ds_read_b64 v[148:149], v11 offset:1432
    ds_read_b64 v[150:151], v11 offset:1528
    s_waitcnt lgkmcnt(8)
    v_mfma_f32_16x16x32_bf16 v[24:27], v[104:107], v[152:155], v[24:27]
    ds_read_b64 v[152:153], v11 offset:1208
    ds_read_b64 v[154:155], v11 offset:1304
    v_mfma_f32_16x16x32_bf16 v[76:79], v[40:43], v[124:127], 0
    v_cvt_pk_bf16_f32 v108, v72, v73
    v_cvt_pk_bf16_f32 v109, v74, v75
    v_mfma_f32_16x16x32_bf16 v[80:83], v[40:43], v[128:131], 0
    v_mfma_f32_16x16x32_bf16 v[84:87], v[44:47], v[124:127], 0
    s_waitcnt lgkmcnt(8)
    v_mfma_f32_16x16x32_bf16 v[28:31], v[104:107], v[156:159], v[28:31]
    s_nop 1
    v_cvt_pk_bf16_f32 v110, v76, v77
    v_cvt_pk_bf16_f32 v111, v78, v79
    ds_read_b64 v[156:157], v11 offset:1400
    ds_read_b64 v[158:159], v11 offset:1496
    s_waitcnt lgkmcnt(6)
    v_mfma_f32_16x16x32_bf16 v[24:27], v[108:111], v[144:147], v[24:27]
    v_cvt_pk_bf16_f32 v112, v80, v81
    v_cvt_pk_bf16_f32 v113, v82, v83
    v_cvt_pk_bf16_f32 v114, v84, v85
    v_cvt_pk_bf16_f32 v115, v86, v87
    v_mfma_f32_16x16x32_bf16 v[28:31], v[160:163], v[40:43], v[28:31]
    ds_read_b64 v[144:145], v11 offset:1720
    ds_read_b64 v[146:147], v11 offset:1880
    s_waitcnt lgkmcnt(6)
    v_mfma_f32_16x16x32_bf16 v[24:27], v[112:115], v[148:151], v[24:27]
    ds_read_b64 v[148:149], v11 offset:1272
    ds_read_b64 v[150:151], v11 offset:1368
    s_waitcnt lgkmcnt(6)
    v_mfma_f32_16x16x32_bf16 v[28:31], v[108:111], v[152:155], v[28:31]
    ds_read_b64 v[152:153], v11 offset:1464
    ds_read_b64 v[154:155], v11 offset:1560
    v_mfma_f32_16x16x32_bf16 v[88:91], v[40:43], v[132:135], 0
    ds_read_b128 v[40:43], v12 offset:3616
    v_mfma_f32_16x16x32_bf16 v[92:95], v[44:47], v[136:139], 0
    ds_read_b128 v[44:47], v12 offset:3600
    v_mfma_f32_16x16x32_bf16 v[48:51], v[32:35], v[120:123], 0
    v_mfma_f32_16x16x32_bf16 v[52:55], v[32:35], v[124:127], 0
    s_nop 2
    v_cvt_pk_bf16_f32 v116, v88, v89
    v_cvt_pk_bf16_f32 v117, v90, v91
    v_mfma_f32_16x16x32_bf16 v[56:59], v[32:35], v[128:131], 0
    v_cvt_pk_bf16_f32 v118, v92, v93
    v_cvt_pk_bf16_f32 v119, v94, v95
    v_mfma_f32_16x16x32_bf16 v[60:63], v[36:39], v[124:127], 0
    v_cvt_pk_bf16_f32 v96, v48, v49
    v_cvt_pk_bf16_f32 v97, v50, v51
    s_waitcnt lgkmcnt(8)
    v_mfma_f32_16x16x32_bf16 v[28:31], v[112:115], v[156:159], v[28:31]
    ds_read_b64 v[156:157], v11 offset:1240
    ds_read_b64 v[158:159], v11 offset:1336
    s_waitcnt lgkmcnt(8)
    v_mfma_f32_16x16x32_bf16 v[28:31], v[116:119], v[144:147], v[28:31]
    v_cvt_pk_bf16_f32 v98, v52, v53
    v_cvt_pk_bf16_f32 v99, v54, v55
    ds_read_b64 v[144:145], v11 offset:1432
    s_waitcnt lgkmcnt(7)
    v_mfma_f32_16x16x32_bf16 v[24:27], v[96:99], v[148:151], v[24:27]
    ds_read_b64 v[146:147], v11 offset:1528
    v_cvt_pk_bf16_f32 v100, v56, v57
    v_cvt_pk_bf16_f32 v101, v58, v59
    v_cvt_pk_bf16_f32 v102, v60, v61
    v_cvt_pk_bf16_f32 v103, v62, v63
    ds_read_b64 v[148:149], v11 offset:1272
    s_waitcnt lgkmcnt(7)
    v_mfma_f32_16x16x32_bf16 v[24:27], v[100:103], v[152:155], v[24:27]
    ds_read_b64 v[150:151], v11 offset:1368
    ds_read_b64 v[152:153], v11 offset:1464
    ds_read_b64 v[154:155], v11 offset:1560
    s_waitcnt lgkmcnt(9)
    v_mfma_f32_16x16x32_bf16 v[72:75], v[40:43], v[120:123], 0
    v_mfma_f32_16x16x32_bf16 v[76:79], v[40:43], v[124:127], 0
    s_nop 1
    v_fmac_f32 v24, s56, v164
    v_fmac_f32 v25, s56, v165
    v_fmac_f32 v26, s56, v166
    v_mfma_f32_16x16x32_bf16 v[80:83], v[40:43], v[128:131], 0
    v_fmac_f32 v27, s56, v167
    v_cvt_pk_bf16_f32 v108, v72, v73
    s_waitcnt lgkmcnt(8)
    v_mfma_f32_16x16x32_bf16 v[84:87], v[44:47], v[124:127], 0
    v_cvt_pk_bf16_f32 v109, v74, v75
    v_cvt_pk_bf16_f32 v110, v76, v77
    s_waitcnt lgkmcnt(6)
    v_mfma_f32_16x16x32_bf16 v[28:31], v[96:99], v[156:159], v[28:31]
    v_cvt_pk_bf16_f32 v111, v78, v79
    v_lshlrev_b32 v164, 16, v4
    v_cvt_pk_bf16_f32 v112, v80, v81
    s_waitcnt lgkmcnt(4)
    v_mfma_f32_16x16x32_bf16 v[28:31], v[100:103], v[144:147], v[28:31]
    v_cvt_pk_bf16_f32 v113, v82, v83
    v_and_b32 v165, 0xffff0000, v4
    v_cvt_pk_bf16_f32 v114, v84, v85
    v_cvt_pk_bf16_f32 v115, v86, v87
    s_waitcnt lgkmcnt(2)
    v_mfma_f32_16x16x32_bf16 v[28:31], v[108:111], v[148:151], v[28:31]
    v_lshlrev_b32 v166, 16, v5
    v_and_b32 v167, 0xffff0000, v5
    v_cvt_pk_bf16_f32 v6, v24, v25
    s_waitcnt lgkmcnt(0)
    v_mfma_f32_16x16x32_bf16 v[28:31], v[112:115], v[152:155], v[28:31]
    v_cvt_pk_bf16_f32 v7, v26, v27
    s_nop 6
    v_fmac_f32 v28, s56, v164
    v_fmac_f32 v29, s56, v165
    v_fmac_f32 v30, s56, v166
    v_fmac_f32 v31, s56, v167
    v_cvt_pk_bf16_f32 v8, v28, v29
    v_cvt_pk_bf16_f32 v9, v30, v31
    s_nop 0
    v_permlane16_swap_b32 v6, v8
    v_permlane16_swap_b32 v7, v9
    buffer_store_dwordx4 v[6:9], v14, s[8:11], 0 offen offset:3072 sc1
    s_endpgm
L_cv_h1:
    ds_read_b64 v[32:33], v10 offset:1112
    ds_read_b64 v[34:35], v10 offset:1120
    ds_read_b128 v[104:107], v12 offset:3648
    ds_read_b64 v[36:37], v10 offset:1048
    ds_read_b64 v[38:39], v10 offset:1056
    ds_read_b128 v[108:111], v12 offset:3584
    ds_read_b64 v[40:41], v10 offset:984
    ds_read_b64 v[42:43], v10 offset:992
    ds_read_b128 v[112:115], v12 offset:3520
    ds_read_b64 v[44:45], v10 offset:920
    ds_read_b64 v[46:47], v10 offset:928
    ds_read_b128 v[116:119], v12 offset:3456
    ds_read_b64 v[48:49], v10 offset:856
    ds_read_b64 v[50:51], v10 offset:864
    s_waitcnt lgkmcnt(11)
    v_mfma_f32_16x16x32_bf16 v[28:31], v[32:35], v[104:107], 0
    ds_read_b128 v[104:107], v12 offset:3392
    ds_read_b64 v[52:53], v10 offset:792
    ds_read_b64 v[54:55], v10 offset:800
    s_waitcnt lgkmcnt(11)
    v_mfma_f32_16x16x32_bf16 v[28:31], v[36:39], v[108:111], v[28:31]
    ds_read_b128 v[108:111], v12 offset:3328
    ds_read_b64 v[56:57], v10 offset:728
    s_waitcnt lgkmcnt(10)
    v_mfma_f32_16x16x32_bf16 v[28:31], v[40:43], v[112:115], v[28:31]
    ds_read_b64 v[58:59], v10 offset:736
    ds_read_b128 v[112:115], v12 offset:3264
    ds_read_b64 v[60:61], v10 offset:664
    s_waitcnt lgkmcnt(10)
    v_mfma_f32_16x16x32_bf16 v[28:31], v[44:47], v[116:119], v[28:31]
    ds_read_b64 v[62:63], v10 offset:672
    ds_read_b128 v[116:119], v12 offset:3200
    ds_read_b64 v[64:65], v10 offset:600
    ds_read_b64 v[66:67], v10 offset:608
    s_waitcnt lgkmcnt(11)
    v_mfma_f32_16x16x32_bf16 v[28:31], v[48:51], v[104:107], v[28:31]
    ds_read_b128 v[104:107], v12 offset:3136
    ds_read_b64 v[68:69], v10 offset:536
    ds_read_b64 v[70:71], v10 offset:544
    s_waitcnt lgkmcnt(11)
    v_mfma_f32_16x16x32_bf16 v[28:31], v[52:55], v[108:111], v[28:31]
    ds_read_b128 v[108:111], v12 offset:3072
    ds_read_b64 v[72:73], v10 offset:472
    ds_read_b64 v[74:75], v10 offset:480
    s_waitcnt lgkmcnt(11)
    v_mfma_f32_16x16x32_bf16 v[28:31], v[56:59], v[112:115], v[28:31]
    ds_read_b128 v[112:115], v12 offset:3008
    ds_read_b64 v[76:77], v10 offset:408
    ds_read_b64 v[78:79], v10 offset:416
    s_waitcnt lgkmcnt(11)
    v_mfma_f32_16x16x32_bf16 v[28:31], v[60:63], v[116:119], v[28:31]
    ds_read_b128 v[116:119], v12 offset:2944
    ds_read_b64 v[80:81], v10 offset:344
    ds_read_b64 v[82:83], v10 offset:352
    s_waitcnt lgkmcnt(11)
    v_mfma_f32_16x16x32_bf16 v[24:27], v[32:35], v[104:107], 0
    ds_read_b64 v[84:85], v10 offset:280
    ds_read_b64 v[86:87], v10 offset:288
    v_mfma_f32_16x16x32_bf16 v[28:31], v[64:67], v[104:107], v[28:31]
    ds_read_b128 v[104:107], v12 offset:2880
    s_waitcnt lgkmcnt(11)
    v_mfma_f32_16x16x32_bf16 v[24:27], v[36:39], v[108:111], v[24:27]
    ds_read_b64 v[88:89], v10 offset:216
    ds_read_b64 v[90:91], v10 offset:224
    v_mfma_f32_16x16x32_bf16 v[28:31], v[68:71], v[108:111], v[28:31]
    ds_read_b128 v[108:111], v12 offset:2816
    s_waitcnt lgkmcnt(11)
    v_mfma_f32_16x16x32_bf16 v[24:27], v[40:43], v[112:115], v[24:27]
    ds_read_b64 v[92:93], v10 offset:152
    ds_read_b64 v[94:95], v10 offset:160
    v_mfma_f32_16x16x32_bf16 v[28:31], v[72:75], v[112:115], v[28:31]
    ds_read_b128 v[112:115], v12 offset:2752
    s_waitcnt lgkmcnt(11)
    v_mfma_f32_16x16x32_bf16 v[24:27], v[44:47], v[116:119], v[24:27]
    ds_read_b64 v[96:97], v10 offset:88
    ds_read_b64 v[98:99], v10 offset:96
    v_mfma_f32_16x16x32_bf16 v[28:31], v[76:79], v[116:119], v[28:31]
    ds_read_b128 v[116:119], v12 offset:2688
    s_waitcnt lgkmcnt(9)
    v_mfma_f32_16x16x32_bf16 v[24:27], v[48:51], v[104:107], v[24:27]
    ds_read_b64 v[100:101], v10 offset:24
    ds_read_b64 v[102:103], v10 offset:32
    v_mfma_f32_16x16x32_bf16 v[28:31], v[80:83], v[104:107], v[28:31]
    ds_read_b128 v[104:107], v12 offset:2624
    ds_read_b64 v[144:145], v11 offset:1272
    s_waitcnt lgkmcnt(10)
    v_mfma_f32_16x16x32_bf16 v[24:27], v[52:55], v[108:111], v[24:27]
    ds_read_b64 v[146:147], v11 offset:1368
    ds_read_b64 v[148:149], v11 offset:1464
    v_mfma_f32_16x16x32_bf16 v[28:31], v[84:87], v[108:111], v[28:31]
    ds_read_b128 v[108:111], v12 offset:2560
    s_waitcnt lgkmcnt(10)
    v_mfma_f32_16x16x32_bf16 v[24:27], v[56:59], v[112:115], v[24:27]
    ds_read_b64 v[150:151], v11 offset:1560
    ds_read_b64 v[152:153], v11 offset:1240
    v_mfma_f32_16x16x32_bf16 v[28:31], v[88:91], v[112:115], v[28:31]
    ds_read_b128 v[112:115], v12 offset:2496
    s_waitcnt lgkmcnt(10)
    v_mfma_f32_16x16x32_bf16 v[24:27], v[60:63], v[116:119], v[24:27]
    ds_read_b64 v[154:155], v11 offset:1336
    ds_read_b64 v[156:157], v11 offset:1432
    v_mfma_f32_16x16x32_bf16 v[28:31], v[92:95], v[116:119], v[28:31]
    ds_read_b128 v[116:119], v12 offset:2432
    ds_read_b64 v[158:159], v11 offset:1528
    s_waitcnt lgkmcnt(11)
    v_mfma_f32_16x16x32_bf16 v[20:23], v[32:35], v[104:107], 0
    ds_read_b64 v[2:3], v13 offset:2112
    ds_read_b64 v[4:5], v13 offset:2624
    v_mfma_f32_16x16x32_bf16 v[24:27], v[64:67], v[104:107], v[24:27]
    v_mfma_f32_16x16x32_bf16 v[28:31], v[96:99], v[104:107], v[28:31]
    ds_read_b128 v[104:107], v12 offset:2368
    s_waitcnt lgkmcnt(10)
    v_mfma_f32_16x16x32_bf16 v[20:23], v[36:39], v[108:111], v[20:23]
    v_mfma_f32_16x16x32_bf16 v[24:27], v[68:71], v[108:111], v[24:27]
    v_mfma_f32_16x16x32_bf16 v[28:31], v[100:103], v[108:111], v[28:31]
    ds_read_b128 v[108:111], v12 offset:2304
    s_waitcnt lgkmcnt(8)
    v_mfma_f32_16x16x32_bf16 v[20:23], v[40:43], v[112:115], v[20:23]
    v_mfma_f32_16x16x32_bf16 v[24:27], v[72:75], v[112:115], v[24:27]
    ds_read_b128 v[112:115], v12 offset:2240
    s_waitcnt lgkmcnt(6)
    v_mfma_f32_16x16x32_bf16 v[20:23], v[44:47], v[116:119], v[20:23]
    s_waitcnt lgkmcnt(4)
    v_lshlrev_b32 v164, 16, v2
    v_and_b32 v165, 0xffff0000, v2
    v_lshlrev_b32 v166, 16, v3
    v_mfma_f32_16x16x32_bf16 v[24:27], v[76:79], v[116:119], v[24:27]
    ds_read_b128 v[116:119], v12 offset:2176
    v_and_b32 v167, 0xffff0000, v3
    s_waitcnt lgkmcnt(3)
    v_mfma_f32_16x16x32_bf16 v[20:23], v[48:51], v[104:107], v[20:23]
    ds_read_b64 v[2:3], v13 offset:3136
    v_mfma_f32_16x16x32_bf16 v[24:27], v[80:83], v[104:107], v[24:27]
    ds_read_b128 v[104:107], v12 offset:2112
    s_waitcnt lgkmcnt(4)
    v_mfma_f32_16x16x32_bf16 v[20:23], v[52:55], v[108:111], v[20:23]
    v_mfma_f32_16x16x32_bf16 v[24:27], v[84:87], v[108:111], v[24:27]
    ds_read_b128 v[108:111], v12 offset:2048
    s_waitcnt lgkmcnt(4)
    v_mfma_f32_16x16x32_bf16 v[20:23], v[56:59], v[112:115], v[20:23]
    v_mfma_f32_16x16x32_bf16 v[24:27], v[88:91], v[112:115], v[24:27]
    ds_read_b128 v[112:115], v12 offset:1984
    s_waitcnt lgkmcnt(4)
    v_mfma_f32_16x16x32_bf16 v[20:23], v[60:63], v[116:119], v[20:23]
    v_mfma_f32_16x16x32_bf16 v[24:27], v[92:95], v[116:119], v[24:27]
    ds_read_b128 v[116:119], v12 offset:1920
    s_waitcnt lgkmcnt(3)
    v_mfma_f32_16x16x32_bf16 v[16:19], v[32:35], v[104:107], 0
    ds_read_b128 v[32:35], v12 offset:1056
    v_mfma_f32_16x16x32_bf16 v[20:23], v[64:67], v[104:107], v[20:23]
    v_mfma_f32_16x16x32_bf16 v[24:27], v[96:99], v[104:107], v[24:27]
    ds_read_b128 v[104:107], v12 offset:1856
    s_waitcnt lgkmcnt(4)
    v_mfma_f32_16x16x32_bf16 v[16:19], v[36:39], v[108:111], v[16:19]
    ds_read_b128 v[36:39], v12 offset:1040
    v_mfma_f32_16x16x32_bf16 v[20:23], v[68:71], v[108:111], v[20:23]
    v_mfma_f32_16x16x32_bf16 v[24:27], v[100:103], v[108:111], v[24:27]
    ds_read_b128 v[108:111], v12 offset:1792
    s_waitcnt lgkmcnt(5)
    v_mfma_f32_16x16x32_bf16 v[16:19], v[40:43], v[112:115], v[16:19]
    ds_read_b128 v[40:43], v12 offset:1568
    v_mfma_f32_16x16x32_bf16 v[20:23], v[72:75], v[112:115], v[20:23]
    ds_read_b128 v[112:115], v12 offset:1728
    s_waitcnt lgkmcnt(6)
    v_mfma_f32_16x16x32_bf16 v[16:19], v[44:47], v[116:119], v[16:19]
    ds_read_b128 v[44:47], v12 offset:1552
    v_mfma_f32_16x16x32_bf16 v[20:23], v[76:79], v[116:119], v[20:23]
    ds_read_b128 v[116:119], v12 offset:1664
    s_waitcnt lgkmcnt(7)
    v_mfma_f32_16x16x32_bf16 v[24:27], v[160:163], v[32:35], v[24:27]
    s_waitcnt lgkmcnt(6)
    v_mfma_f32_16x16x32_bf16 v[16:19], v[48:51], v[104:107], v[16:19]
    v_mfma_f32_16x16x32_bf16 v[20:23], v[80:83], v[104:107], v[20:23]
    ds_read_b128 v[104:107], v12 offset:1600
    v_mfma_f32_16x16x32_bf16 v[48:51], v[32:35], v[120:123], 0
    s_waitcnt lgkmcnt(5)
    v_mfma_f32_16x16x32_bf16 v[16:19], v[52:55], v[108:111], v[16:19]
    v_mfma_f32_16x16x32_bf16 v[20:23], v[84:87], v[108:111], v[20:23]
    ds_read_b128 v[108:111], v12 offset:1536
    s_waitcnt lgkmcnt(4)
    v_mfma_f32_16x16x32_bf16 v[16:19], v[56:59], v[112:115], v[16:19]
    v_mfma_f32_16x16x32_bf16 v[20:23], v[88:91], v[112:115], v[20:23]
    ds_read_b128 v[112:115], v12 offset:1472
    s_waitcnt lgkmcnt(3)
    v_mfma_f32_16x16x32_bf16 v[16:19], v[60:63], v[116:119], v[16:19]
    v_mfma_f32_16x16x32_bf16 v[20:23], v[92:95], v[116:119], v[20:23]
    ds_read_b128 v[116:119], v12 offset:1408
    v_mfma_f32_16x16x32_bf16 v[52:55], v[32:35], v[124:127], 0
    s_waitcnt lgkmcnt(3)
    v_mfma_f32_16x16x32_bf16 v[16:19], v[64:67], v[104:107], v[16:19]
    v_mfma_f32_16x16x32_bf16 v[20:23], v[96:99], v[104:107], v[20:23]
    ds_read_b128 v[104:107], v12 offset:1344
    v_mfma_f32_16x16x32_bf16 v[56:59], v[32:35], v[128:131], 0
    s_waitcnt lgkmcnt(3)
    v_mfma_f32_16x16x32_bf16 v[16:19], v[68:71], v[108:111], v[16:19]
    v_mfma_f32_16x16x32_bf16 v[20:23], v[100:103], v[108:111], v[20:23]
    ds_read_b128 v[108:111], v12 offset:1280
    s_waitcnt lgkmcnt(3)
    v_mfma_f32_16x16x32_bf16 v[16:19], v[72:75], v[112:115], v[16:19]
    ds_read_b128 v[112:115], v12 offset:1216
    v_mfma_f32_16x16x32_bf16 v[60:63], v[36:39], v[124:127], 0
    s_waitcnt lgkmcnt(3)
    v_mfma_f32_16x16x32_bf16 v[16:19], v[76:79], v[116:119], v[16:19]
    ds_read_b128 v[116:119], v12 offset:1152
    v_mfma_f32_16x16x32_bf16 v[64:67], v[32:35], v[132:135], 0
    ds_read_b128 v[32:35], v12 offset:2080
    v_mfma_f32_16x16x32_bf16 v[68:71], v[36:39], v[136:139], 0
    ds_read_b128 v[36:39], v12 offset:2064
    s_waitcnt lgkmcnt(5)
    v_mfma_f32_16x16x32_bf16 v[16:19], v[80:83], v[104:107], v[16:19]
    ds_read_b128 v[104:107], v12 offset:1088
    v_mfma_f32_16x16x32_bf16 v[72:75], v[40:43], v[120:123], 0
    v_mfma_f32_16x16x32_bf16 v[76:79], v[40:43], v[124:127], 0
    s_waitcnt lgkmcnt(5)
    v_mfma_f32_16x16x32_bf16 v[16:19], v[84:87], v[108:111], v[16:19]
    ds_read_b128 v[108:111], v12 offset:1024
    s_waitcnt lgkmcnt(5)
    v_mfma_f32_16x16x32_bf16 v[16:19], v[88:91], v[112:115], v[16:19]
    v_mfma_f32_16x16x32_bf16 v[80:83], v[40:43], v[128:131], 0
    s_waitcnt lgkmcnt(4)
    v_mfma_f32_16x16x32_bf16 v[16:19], v[92:95], v[116:119], v[16:19]
    v_mfma_f32_16x16x32_bf16 v[84:87], v[44:47], v[124:127], 0
    s_nop 4
    v_cvt_pk_bf16_f32 v112, v80, v81
    v_cvt_pk_bf16_f32 v113, v82, v83
    s_waitcnt lgkmcnt(1)
    v_mfma_f32_16x16x32_bf16 v[16:19], v[96:99], v[104:107], v[16:19]
    v_cvt_pk_bf16_f32 v96, v48, v49
    v_cvt_pk_bf16_f32 v97, v50, v51
    v_cvt_pk_bf16_f32 v98, v52, v53
    v_cvt_pk_bf16_f32 v99, v54, v55
    v_cvt_pk_bf16_f32 v104, v64, v65
    v_cvt_pk_bf16_f32 v105, v66, v67
    v_mfma_f32_16x16x32_bf16 v[20:23], v[96:99], v[152:155], v[20:23]
    ds_read_b64 v[152:153], v11 offset:1720
    ds_read_b64 v[154:155], v11 offset:1880
    s_waitcnt lgkmcnt(2)
    v_mfma_f32_16x16x32_bf16 v[16:19], v[100:103], v[108:111], v[16:19]
    v_cvt_pk_bf16_f32 v100, v56, v57
    v_cvt_pk_bf16_f32 v101, v58, v59
    v_mfma_f32_16x16x32_bf16 v[16:19], v[96:99], v[144:147], v[16:19]
    ds_read_b64 v[144:145], v11 offset:1208
    ds_read_b64 v[146:147], v11 offset:1304
    v_cvt_pk_bf16_f32 v102, v60, v61
    v_cvt_pk_bf16_f32 v103, v62, v63
    v_cvt_pk_bf16_f32 v106, v68, v69
    v_cvt_pk_bf16_f32 v107, v70, v71
    v_mfma_f32_16x16x32_bf16 v[16:19], v[100:103], v[148:151], v[16:19]
    ds_read_b64 v[148:149], v11 offset:1400
    ds_read_b64 v[150:151], v11 offset:1496
    v_mfma_f32_16x16x32_bf16 v[20:23], v[100:103], v[156:159], v[20:23]
    ds_read_b64 v[156:157], v11 offset:1688
    ds_read_b64 v[158:159], v11 offset:1848
    v_cvt_pk_bf16_f32 v108, v72, v73
    v_cvt_pk_bf16_f32 v109, v74, v75
    v_cvt_pk_bf16_f32 v110, v76, v77
    v_cvt_pk_bf16_f32 v111, v78, v79
    v_cvt_pk_bf16_f32 v114, v84, v85
    v_cvt_pk_bf16_f32 v115, v86, v87
    v_mfma_f32_16x16x32_bf16 v[88:91], v[40:43], v[132:135], 0
    v_fmac_f32 v16, s56, v164
    v_fmac_f32 v17, s56, v165
    v_fmac_f32 v18, s56, v166
    v_mfma_f32_16x16x32_bf16 v[92:95], v[44:47], v[136:139], 0
    ds_read_b128 v[44:47], v12 offset:2576
    s_waitcnt lgkmcnt(5)
    v_mfma_f32_16x16x32_bf16 v[24:27], v[96:99], v[144:147], v[24:27]
    ds_read_b64 v[144:145], v11 offset:1272
    ds_read_b64 v[146:147], v11 offset:1368
    v_mfma_f32_16x16x32_bf16 v[48:51], v[32:35], v[120:123], 0
    v_cvt_pk_bf16_f32 v116, v88, v89
    v_cvt_pk_bf16_f32 v117, v90, v91
    v_mfma_f32_16x16x32_bf16 v[52:55], v[32:35], v[124:127], 0
    v_cvt_pk_bf16_f32 v118, v92, v93
    v_cvt_pk_bf16_f32 v119, v94, v95
    s_waitcnt lgkmcnt(5)
    v_mfma_f32_16x16x32_bf16 v[24:27], v[100:103], v[148:151], v[24:27]
    ds_read_b64 v[148:149], v11 offset:1464
    ds_read_b64 v[150:151], v11 offset:1560
    v_mfma_f32_16x16x32_bf16 v[24:27], v[104:107], v[152:155], v[24:27]
    ds_read_b64 v[152:153], v11 offset:1240
    ds_read_b64 v[154:155], v11 offset:1336
    s_waitcnt lgkmcnt(7)
    v_mfma_f32_16x16x32_bf16 v[28:31], v[104:107], v[156:159], v[28:31]
    ds_read_b64 v[156:157], v11 offset:1432
    ds_read_b64 v[158:159], v11 offset:1528
    v_mfma_f32_16x16x32_bf16 v[28:31], v[160:163], v[40:43], v[28:31]
    ds_read_b128 v[40:43], v12 offset:2592
    v_mfma_f32_16x16x32_bf16 v[56:59], v[32:35], v[128:131], 0
    v_cvt_pk_bf16_f32 v96, v48, v49
    v_cvt_pk_bf16_f32 v97, v50, v51
    s_waitcnt lgkmcnt(7)
    v_mfma_f32_16x16x32_bf16 v[20:23], v[108:111], v[144:147], v[20:23]
    ds_read_b64 v[144:145], v11 offset:1208
    ds_read_b64 v[146:147], v11 offset:1304
    v_mfma_f32_16x16x32_bf16 v[60:63], v[36:39], v[124:127], 0
    v_cvt_pk_bf16_f32 v98, v52, v53
    v_cvt_pk_bf16_f32 v99, v54, v55
    v_cvt_pk_bf16_f32 v100, v56, v57
    v_cvt_pk_bf16_f32 v101, v58, v59
    v_fmac_f32 v19, s56, v167
    s_waitcnt lgkmcnt(7)
    v_mfma_f32_16x16x32_bf16 v[20:23], v[112:115], v[148:151], v[20:23]
    ds_read_b64 v[148:149], v11 offset:1400
    ds_read_b64 v[150:151], v11 offset:1496
    s_waitcnt lgkmcnt(7)
    v_mfma_f32_16x16x32_bf16 v[24:27], v[108:111], v[152:155], v[24:27]
    ds_read_b64 v[152:153], v11 offset:1720
    ds_read_b64 v[154:155], v11 offset:1880
    s_waitcnt lgkmcnt(7)
    v_mfma_f32_16x16x32_bf16 v[24:27], v[112:115], v[156:159], v[24:27]
    ds_read_b64 v[156:157], v11 offset:1272
    ds_read_b64 v[158:159], v11 offset:1368
    v_cvt_pk_bf16_f32 v102, v60, v61
    v_cvt_pk_bf16_f32 v103, v62, v63
    v_lshlrev_b32 v164, 16, v4
    v_and_b32 v165, 0xffff0000, v4
    v_lshlrev_b32 v166, 16, v5
    v_and_b32 v167, 0xffff0000, v5
    ds_read_b64 v[4:5], v13 offset:3648
    s_waitcnt lgkmcnt(7)
    v_mfma_f32_16x16x32_bf16 v[28:31], v[108:111], v[144:147], v[28:31]
    ds_read_b64 v[144:145], v11 offset:1464
    ds_read_b64 v[146:147], v11 offset:1560
    v_mfma_f32_16x16x32_bf16 v[72:75], v[40:43], v[120:123], 0
    v_fmac_f32 v20, s56, v164
    v_fmac_f32 v21, s56, v165
    v_mfma_f32_16x16x32_bf16 v[76:79], v[40:43], v[124:127], 0
    v_fmac_f32 v22, s56, v166
    v_fmac_f32 v23, s56, v167
    s_waitcnt lgkmcnt(7)
    v_mfma_f32_16x16x32_bf16 v[28:31], v[112:115], v[148:151], v[28:31]
    ds_read_b64 v[148:149], v11 offset:1240
    ds_read_b64 v[150:151], v11 offset:1336
    s_waitcnt lgkmcnt(7)
    v_mfma_f32_16x16x32_bf16 v[28:31], v[116:119], v[152:155], v[28:31]
    ds_read_b64 v[152:153], v11 offset:1432
    ds_read_b64 v[154:155], v11 offset:1528
    s_waitcnt lgkmcnt(7)
    v_mfma_f32_16x16x32_bf16 v[24:27], v[96:99], v[156:159], v[24:27]
    ds_read_b64 v[156:157], v11 offset:1272
    ds_read_b64 v[158:159], v11 offset:1368
    v_mfma_f32_16x16x32_bf16 v[80:83], v[40:43], v[128:131], 0
    v_cvt_pk_bf16_f32 v108, v72, v73
    v_cvt_pk_bf16_f32 v109, v74, v75
    v_mfma_f32_16x16x32_bf16 v[84:87], v[44:47], v[124:127], 0
    v_cvt_pk_bf16_f32 v110, v76, v77
    v_cvt_pk_bf16_f32 v111, v78, v79
    s_waitcnt lgkmcnt(6)
    v_mfma_f32_16x16x32_bf16 v[24:27], v[100:103], v[144:147], v[24:27]
    ds_read_b64 v[144:145], v11 offset:1464
    ds_read_b64 v[146:147], v11 offset:1560
    v_cvt_pk_bf16_f32 v112, v80, v81
    v_cvt_pk_bf16_f32 v113, v82, v83
    v_cvt_pk_bf16_f32 v114, v84, v85
    v_cvt_pk_bf16_f32 v115, v86, v87
    v_cvt_pk_bf16_f32 v6, v16, v17
    v_cvt_pk_bf16_f32 v7, v18, v19
    s_waitcnt lgkmcnt(6)
    v_mfma_f32_16x16x32_bf16 v[28:31], v[96:99], v[148:151], v[28:31]
    v_cvt_pk_bf16_f32 v8, v20, v21
    v_cvt_pk_bf16_f32 v9, v22, v23
    v_lshlrev_b32 v164, 16, v2
    s_waitcnt lgkmcnt(4)
    v_mfma_f32_16x16x32_bf16 v[28:31], v[100:103], v[152:155], v[28:31]
    v_and_b32 v165, 0xffff0000, v2
    v_lshlrev_b32 v166, 16, v3
    v_and_b32 v167, 0xffff0000, v3
    s_waitcnt lgkmcnt(2)
    v_mfma_f32_16x16x32_bf16 v[28:31], v[108:111], v[156:159], v[28:31]
    v_permlane16_swap_b32 v6, v8
    v_permlane16_swap_b32 v7, v9
    v_fmac_f32 v24, s56, v164
    v_fmac_f32 v25, s56, v165
    v_fmac_f32 v26, s56, v166
    v_fmac_f32 v27, s56, v167
    buffer_store_dwordx4 v[6:9], v14, s[8:11], 0 offen offset:1024 sc1
    v_lshlrev_b32 v164, 16, v4
    v_and_b32 v165, 0xffff0000, v4
    s_waitcnt lgkmcnt(0)
    v_mfma_f32_16x16x32_bf16 v[28:31], v[112:115], v[144:147], v[28:31]
    v_lshlrev_b32 v166, 16, v5
    v_and_b32 v167, 0xffff0000, v5
    v_cvt_pk_bf16_f32 v6, v24, v25
    v_cvt_pk_bf16_f32 v7, v26, v27
    s_nop 3
    v_fmac_f32 v28, s56, v164
    v_fmac_f32 v29, s56, v165
    v_fmac_f32 v30, s56, v166
    v_fmac_f32 v31, s56, v167
    v_cvt_pk_bf16_f32 v8, v28, v29
    v_cvt_pk_bf16_f32 v9, v30, v31
    s_nop 0
    v_permlane16_swap_b32 v6, v8
    v_permlane16_swap_b32 v7, v9
    buffer_store_dwordx4 v[6:9], v14, s[8:11], 0 offen offset:2048 sc1
    s_endpgm
L_k2_col:
    v_lshrrev_b32 v1, 6, v0
    v_and_b32 v2, 63, v0
    v_readfirstlane_b32 s3, v1
    s_sub_u32 s48, s2, 0
    s_and_b32 s12, s48, 7
    s_lshl_b32 s12, s12, 1
    s_bfe_u32 s49, s48, 0x10003
    s_add_u32 s12, s12, s49
    s_and_b32 s49, s48, 0xf0
    s_add_u32 s12, s12, s49
    s_lshr_b32 s13, s12, 4
    s_add_u32 s13, s13, 1
    s_and_b32 s14, s12, 15
    s_cmp_ge_u32 s12, 208
    s_cselect_b32 s13, 14, s13
    s_sub_u32 s48, s12, 216
    s_cmp_ge_u32 s12, 216
    s_cselect_b32 s13, 0, s13
    s_cselect_b32 s14, s48, s14
    s_lshl_b32 s15, s13, 4
    s_add_u32 s15, s15, s14
    s_mul_i32 s48, s14, 28
    s_add_u32 s48, s48, s13
    s_sub_u32 s49, 448, s48
    s_cmp_gt_u32 s48, 224
    s_cselect_b32 s50, 1, 0
    s_cselect_b32 s49, s49, s48
    s_lshl_b32 s51, s15, 6
    s_add_u32 s51, s51, 0x0
    v_lshrrev_b32 v3, 2, v0
    v_mul_u32_u24 v3, 16640, v3
    v_and_b32 v4, 3, v0
    v_lshl_add_u32 v3, v4, 4, v3
    v_add_u32 v3, s51, v3
    v_and_b32 v4, 15, v2
    v_lshrrev_b32 v5, 4, v2
    s_lshl_b32 s52, s3, 4
    v_add_u32 v6, s52, v4
    v_lshlrev_b32 v7, 2, v5
    v_sub_u32 v9, 64, v6
    v_and_b32 v9, 63, v9
    v_sub_u32 v8, 12, v7
    v_cmp_eq_u32 vcc, 0, v6
    s_nop 1
    v_addc_co_u32 v8, vcc, 0, v8, vcc
    s_cmp_eq_u32 s50, 1
    s_cselect_b64 vcc, -1, 0
    v_cndmask_b32 v9, v6, v9, vcc
    v_cndmask_b32 v8, v7, v8, vcc
    v_mul_u32_u24 v9, 28928, v9
    v_lshl_add_u32 v8, v8, 2, v9
    s_lshl_b32 s53, s49, 7
    s_add_u32 s53, s53, 0x800000
    v_add_u32 v8, s53, v8
    s_waitcnt lgkmcnt(0)
    s_mov_b32 s8, s46
    s_mov_b32 s9, s47
    s_mov_b32 s10, 0x1200000
    s_mov_b32 s11, 0x20000
    buffer_load_dwordx4 v[96:99], v3, s[8:11], 0 offen
    s_mov_b32 s54, 1064960
    buffer_load_dwordx4 v[100:103], v3, s[8:11], s54 offen
    s_load_dword s55, s[46:47], s53
    s_mov_b32 s56, 0x36124925
    s_cmp_eq_u32 s48, 0
    s_cselect_b32 s56, 0x35924925, s56
    s_cmp_eq_u32 s48, 224
    s_cselect_b32 s56, 0x35924925, s56
    s_mov_b32 s57, s56
    s_lshl_b32 s58, s50, 31
    s_xor_b32 s58, s58, s56
    s_mov_b32 s59, s58
    v_and_b32 v9, 7, v0
    v_lshlrev_b32 v9, 2, v9
    v_lshrrev_b32 v10, 3, v0
    v_xor_b32 v10, v10, v9
    v_lshlrev_b32 v10, 2, v10
    v_mul_u32_u24 v9, 288, v9
    v_add_u32 v9, v9, v10
    v_lshrrev_b32 v10, 2, v4
    v_xor_b32 v10, v10, v5
    v_lshlrev_b32 v10, 4, v10
    v_mul_u32_u24 v11, 288, v4
    v_add_u32 v10, v10, v11
    v_xor_b32 v11, v4, v7
    v_lshlrev_b32 v11, 2, v11
    v_mul_u32_u24 v12, 288, v7
    v_add_u32 v11, v11, v12
    s_lshl_b32 s60, s3, 6
    s_add_u32 s60, s60, 9216
    s_xor_b32 s61, s3, 1
    s_lshl_b32 s61, s61, 6
    s_add_u32 s61, s61, 13824
    v_add_u32 v12, s61, v11
    v_add_u32 v11, s60, v11
    v_and_b32 v13, 7, v4
    v_add_u32 v13, s52, v13
    v_lshlrev_b32 v13, 7, v13
    v_lshrrev_b32 v14, 3, v4
    v_lshl_add_u32 v13, v14, 6, v13
    v_lshl_add_u32 v13, v5, 4, v13
    s_mul_i32 s62, s15, 8448
    s_add_u32 s62, s62, 0xb00000
    v_add_u32 v13, s62, v13
    v_cvt_f32_u32 v14, v6
    v_cvt_f32_u32 v15, v7
    v_mul_f32 v163, 0xbc800000, v14
    v_mul_f32 v165, v15, v163
    v_mov_b32 v160, v165
    v_cos_f32 v161, v160
    v_sin_f32 v162, v160
    s_nop 0
    v_cvt_pk_bf16_f32 v16, v161, -v162
    v_cvt_pk_bf16_f32 v32, v162, v161
    v_fmamk_f32 v160, v163, 0x3f800000, v165
    v_cos_f32 v161, v160
    v_sin_f32 v162, v160
    s_nop 0
    v_cvt_pk_bf16_f32 v17, v161, -v162
    v_cvt_pk_bf16_f32 v33, v162, v161
    v_fmamk_f32 v160, v163, 0x40000000, v165
    v_cos_f32 v161, v160
    v_sin_f32 v162, v160
    s_nop 0
    v_cvt_pk_bf16_f32 v18, v161, -v162
    v_cvt_pk_bf16_f32 v34, v162, v161
    v_fmamk_f32 v160, v163, 0x40400000, v165
    v_cos_f32 v161, v160
    v_sin_f32 v162, v160
    s_nop 0
    v_cvt_pk_bf16_f32 v19, v161, -v162
    v_cvt_pk_bf16_f32 v35, v162, v161
    v_fmamk_f32 v160, v163, 0x41800000, v165
    v_cos_f32 v161, v160
    v_sin_f32 v162, v160
    s_nop 0
    v_cvt_pk_bf16_f32 v20, v161, -v162
    v_cvt_pk_bf16_f32 v36, v162, v161
    v_fmamk_f32 v160, v163, 0x41880000, v165
    v_cos_f32 v161, v160
    v_sin_f32 v162, v160
    s_nop 0
    v_cvt_pk_bf16_f32 v21, v161, -v162
    v_cvt_pk_bf16_f32 v37, v162, v161
    v_fmamk_f32 v160, v163, 0x41900000, v165
    v_cos_f32 v161, v160
    v_sin_f32 v162, v160
    s_nop 0
    v_cvt_pk_bf16_f32 v22, v161, -v162
    v_cvt_pk_bf16_f32 v38, v162, v161
    v_fmamk_f32 v160, v163, 0x41980000, v165
    v_cos_f32 v161, v160
    v_sin_f32 v162, v160
    s_nop 0
    v_cvt_pk_bf16_f32 v23, v161, -v162
    v_cvt_pk_bf16_f32 v39, v162, v161
    v_and_b32 v160, 1, v4
    v_mul_u32_u24 v160, 0x8000, v160
    v_lshl_or_b32 v164, v160, 16, v160
    v_xor_b32 v24, v164, v16
    v_xor_b32 v40, v164, v32
    v_xor_b32 v25, v164, v17
    v_xor_b32 v41, v164, v33
    v_xor_b32 v26, v164, v18
    v_xor_b32 v42, v164, v34
    v_xor_b32 v27, v164, v19
    v_xor_b32 v43, v164, v35
    v_xor_b32 v28, v164, v20
    v_xor_b32 v44, v164, v36
    v_xor_b32 v29, v164, v21
    v_xor_b32 v45, v164, v37
    v_xor_b32 v30, v164, v22
    v_xor_b32 v46, v164, v38
    v_xor_b32 v31, v164, v23
    v_xor_b32 v47, v164, v39
    v_cvt_f32_u32 v163, v4
    v_mul_f32 v163, 0xbd000000, v163
    v_mul_f32 v165, v15, v163
    v_mov_b32 v160, v165
    v_cos_f32 v161, v160
    v_sin_f32 v162, v160
    s_nop 0
    v_cvt_pk_bf16_f32 v48, v161, -v162
    v_cvt_pk_bf16_f32 v64, v162, v161
    v_fmamk_f32 v160, v163, 0x3f800000, v165
    v_cos_f32 v161, v160
    v_sin_f32 v162, v160
    s_nop 0
    v_cvt_pk_bf16_f32 v49, v161, -v162
    v_cvt_pk_bf16_f32 v65, v162, v161
    v_fmamk_f32 v160, v163, 0x40000000, v165
    v_cos_f32 v161, v160
    v_sin_f32 v162, v160
    s_nop 0
    v_cvt_pk_bf16_f32 v50, v161, -v162
    v_cvt_pk_bf16_f32 v66, v162, v161
    v_fmamk_f32 v160, v163, 0x40400000, v165
    v_cos_f32 v161, v160
    v_sin_f32 v162, v160
    s_nop 0
    v_cvt_pk_bf16_f32 v51, v161, -v162
    v_cvt_pk_bf16_f32 v67, v162, v161
    s_mov_b32 s63, 0x80008000
    v_xor_b32 v52, v164, v48
    v_xor_b32 v53, v164, v49
    v_xor_b32 v54, v164, v50
    v_xor_b32 v55, v164, v51
    v_mov_b32 v56, v48
    v_xor_b32 v57, s63, v49
    v_mov_b32 v58, v50
    v_xor_b32 v59, s63, v51
    v_mov_b32 v60, v52
    v_xor_b32 v61, s63, v53
    v_mov_b32 v62, v54
    v_xor_b32 v63, s63, v55
    v_xor_b32 v68, v164, v64
    v_xor_b32 v69, v164, v65
    v_xor_b32 v70, v164, v66
    v_xor_b32 v71, v164, v67
    v_mov_b32 v72, v64
    v_xor_b32 v73, s63, v65
    v_mov_b32 v74, v66
    v_xor_b32 v75, s63, v67
    v_mov_b32 v76, v68
    v_xor_b32 v77, s63, v69
    v_mov_b32 v78, v70
    v_xor_b32 v79, s63, v71
    v_mul_f32 v163, 0xba000000, v14
    v_mul_f32 v165, v15, v163
    v_mov_b32 v160, v165
    v_cos_f32 v80, v160
    v_sin_f32 v88, v160
    v_fmamk_f32 v160, v163, 0x3f800000, v165
    v_cos_f32 v81, v160
    v_sin_f32 v89, v160
    v_fmamk_f32 v160, v163, 0x40000000, v165
    v_cos_f32 v82, v160
    v_sin_f32 v90, v160
    v_fmamk_f32 v160, v163, 0x40400000, v165
    v_cos_f32 v83, v160
    v_sin_f32 v91, v160
    v_fmamk_f32 v160, v163, 0x41800000, v165
    v_cos_f32 v84, v160
    v_sin_f32 v92, v160
    v_fmamk_f32 v160, v163, 0x41880000, v165
    v_cos_f32 v85, v160
    v_sin_f32 v93, v160
    v_fmamk_f32 v160, v163, 0x41900000, v165
    v_cos_f32 v86, v160
    v_sin_f32 v94, v160
    v_fmamk_f32 v160, v163, 0x41980000, v165
    v_cos_f32 v87, v160
    v_sin_f32 v95, v160
    s_waitcnt vmcnt(0)
    buffer_load_dwordx4 v[152:155], v8, s[8:11], 0 offen
    buffer_load_dwordx4 v[156:159], v8, s[8:11], 0 offen offset:64
    ds_write_b32 v9, v96 offset:0
    ds_write_b32 v9, v97 offset:288
    ds_write_b32 v9, v98 offset:576
    ds_write_b32 v9, v99 offset:864
    ds_write_b32 v9, v100 offset:128
    ds_write_b32 v9, v101 offset:416
    ds_write_b32 v9, v102 offset:704
    ds_write_b32 v9, v103 offset:992
    s_waitcnt lgkmcnt(0)
    s_barrier
    ds_read_b128 v[96:99], v10 offset:0
    ds_read_b128 v[112:115], v10 offset:4672
    ds_read_b128 v[100:103], v10 offset:64
    ds_read_b128 v[116:119], v10 offset:4608
    ds_read_b128 v[104:107], v10 offset:128
    ds_read_b128 v[120:123], v10 offset:4800
    ds_read_b128 v[108:111], v10 offset:192
    ds_read_b128 v[124:127], v10 offset:4736
    s_waitcnt lgkmcnt(7)
    v_mfma_f32_16x16x32_bf16 v[128:131], v[96:99], v[16:19], 0
    v_mfma_f32_16x16x32_bf16 v[136:139], v[96:99], v[32:35], 0
    s_waitcnt lgkmcnt(6)
    v_mfma_f32_16x16x32_bf16 v[132:135], v[112:115], v[16:19], 0
    s_waitcnt lgkmcnt(5)
    v_mfma_f32_16x16x32_bf16 v[128:131], v[100:103], v[20:23], v[128:131]
    v_mfma_f32_16x16x32_bf16 v[140:143], v[112:115], v[32:35], 0
    v_mfma_f32_16x16x32_bf16 v[136:139], v[100:103], v[36:39], v[136:139]
    s_waitcnt lgkmcnt(4)
    v_mfma_f32_16x16x32_bf16 v[132:135], v[116:119], v[20:23], v[132:135]
    s_waitcnt lgkmcnt(3)
    v_mfma_f32_16x16x32_bf16 v[128:131], v[104:107], v[24:27], v[128:131]
    v_mfma_f32_16x16x32_bf16 v[140:143], v[116:119], v[36:39], v[140:143]
    v_mfma_f32_16x16x32_bf16 v[136:139], v[104:107], v[40:43], v[136:139]
    s_waitcnt lgkmcnt(2)
    v_mfma_f32_16x16x32_bf16 v[132:135], v[120:123], v[24:27], v[132:135]
    s_waitcnt lgkmcnt(1)
    v_mfma_f32_16x16x32_bf16 v[128:131], v[108:111], v[28:31], v[128:131]
    v_mfma_f32_16x16x32_bf16 v[140:143], v[120:123], v[40:43], v[140:143]
    v_mfma_f32_16x16x32_bf16 v[136:139], v[108:111], v[44:47], v[136:139]
    s_waitcnt lgkmcnt(0)
    v_mfma_f32_16x16x32_bf16 v[132:135], v[124:127], v[28:31], v[132:135]
    s_nop 3
    v_mul_f32 v160, v128, v80
    v_mul_f32 v161, v128, v88
    v_mul_f32 v162, v129, v81
    v_mfma_f32_16x16x32_bf16 v[140:143], v[124:127], v[44:47], v[140:143]
    v_mul_f32 v163, v129, v89
    v_fma_f32 v128, -v136, v88, v160
    v_fma_f32 v129, -v137, v89, v162
    v_fma_f32 v136, v136, v80, v161
    v_fma_f32 v137, v137, v81, v163
    v_mul_f32 v160, v130, v82
    v_mul_f32 v161, v130, v90
    v_mul_f32 v162, v131, v83
    v_mul_f32 v163, v131, v91
    v_mul_f32 v164, v132, v84
    v_mul_f32 v165, v132, v92
    v_mul_f32 v166, v133, v85
    v_mul_f32 v167, v133, v93
    v_fma_f32 v130, -v138, v90, v160
    v_fma_f32 v131, -v139, v91, v162
    v_fma_f32 v132, -v140, v92, v164
    v_fma_f32 v133, -v141, v93, v166
    v_fma_f32 v138, v138, v82, v161
    v_fma_f32 v139, v139, v83, v163
    v_fma_f32 v140, v140, v84, v165
    v_fma_f32 v141, v141, v85, v167
    v_cvt_pk_bf16_f32 v144, v128, v136
    v_cvt_pk_bf16_f32 v145, v129, v137
    v_cvt_pk_bf16_f32 v146, v130, v138
    v_cvt_pk_bf16_f32 v147, v131, v139
    v_mul_f32 v164, v134, v86
    v_mul_f32 v165, v134, v94
    v_mul_f32 v166, v135, v87
    v_mul_f32 v167, v135, v95
    v_fma_f32 v134, -v142, v94, v164
    v_fma_f32 v135, -v143, v95, v166
    v_fma_f32 v142, v142, v86, v165
    v_fma_f32 v143, v143, v87, v167
    v_mfma_f32_16x16x32_bf16 v[96:99], v[48:51], v[144:147], 0
    v_cvt_pk_bf16_f32 v148, v132, v140
    v_cvt_pk_bf16_f32 v149, v133, v141
    v_mfma_f32_16x16x32_bf16 v[104:107], v[64:67], v[144:147], 0
    v_cvt_pk_bf16_f32 v150, v134, v142
    v_cvt_pk_bf16_f32 v151, v135, v143
    v_mfma_f32_16x16x32_bf16 v[100:103], v[56:59], v[144:147], 0
    v_mfma_f32_16x16x32_bf16 v[108:111], v[72:75], v[144:147], 0
    v_mfma_f32_16x16x32_bf16 v[96:99], v[52:55], v[148:151], v[96:99]
    v_mfma_f32_16x16x32_bf16 v[104:107], v[68:71], v[148:151], v[104:107]
    v_mfma_f32_16x16x32_bf16 v[100:103], v[60:63], v[148:151], v[100:103]
    v_mfma_f32_16x16x32_bf16 v[108:111], v[76:79], v[148:151], v[108:111]
    s_waitcnt vmcnt(0)
    s_cmp_eq_u32 s50, 0
    s_cbranch_scc1 L_col_norev
    v_swap_b32 v152, v159
    v_swap_b32 v153, v158
    v_swap_b32 v154, v157
    v_swap_b32 v155, v156
    s_cmp_eq_u32 s3, 0
    s_cbranch_scc0 L_col_norev
    v_writelane_b32 v152, s55, 0
L_col_norev:
    v_lshlrev_b32 v112, 16, v152
    v_and_b32 v120, 0xffff0000, v152
    v_lshlrev_b32 v113, 16, v153
    v_and_b32 v121, 0xffff0000, v153
    v_mul_f32 v112, s56, v112
    v_mul_f32 v120, s58, v120
    v_mul_f32 v113, s56, v113
    v_mul_f32 v121, s58, v121
    v_mul_f32 v160, v96, v112
    v_mul_f32 v161, v96, v120
    v_mul_f32 v162, v97, v113
    v_mul_f32 v163, v97, v121
    v_lshlrev_b32 v114, 16, v154
    v_and_b32 v122, 0xffff0000, v154
    v_lshlrev_b32 v115, 16, v155
    v_and_b32 v123, 0xffff0000, v155
    v_fma_f32 v96, -v104, v120, v160
    v_fma_f32 v97, -v105, v121, v162
    v_lshlrev_b32 v116, 16, v156
    v_and_b32 v124, 0xffff0000, v156
    v_lshlrev_b32 v117, 16, v157
    v_and_b32 v125, 0xffff0000, v157
    v_mul_f32 v114, s56, v114
    v_mul_f32 v122, s58, v122
    v_mul_f32 v115, s56, v115
    v_mul_f32 v123, s58, v123
    v_fma_f32 v104, v104, v112, v161
    v_fma_f32 v105, v105, v113, v163
    v_mul_f32 v116, s56, v116
    v_mul_f32 v124, s58, v124
    v_mul_f32 v117, s56, v117
    v_mul_f32 v125, s58, v125
    v_mul_f32 v160, v98, v114
    v_mul_f32 v161, v98, v122
    v_mul_f32 v162, v99, v115
    v_mul_f32 v163, v99, v123
    v_mul_f32 v164, v100, v116
    v_mul_f32 v165, v100, v124
    v_mul_f32 v166, v101, v117
    v_mul_f32 v167, v101, v125
    v_fma_f32 v98, -v106, v122, v160
    v_fma_f32 v99, -v107, v123, v162
    v_lshlrev_b32 v118, 16, v158
    v_and_b32 v126, 0xffff0000, v158
    v_lshlrev_b32 v119, 16, v159
    v_and_b32 v127, 0xffff0000, v159
    v_fma_f32 v100, -v108, v124, v164
    v_fma_f32 v101, -v109, v125, v166
    v_fma_f32 v106, v106, v114, v161
    v_fma_f32 v107, v107, v115, v163
    v_mul_f32 v118, s56, v118
    v_mul_f32 v126, s58, v126
    v_mul_f32 v119, s56, v119
    v_mul_f32 v127, s58, v127
    v_fma_f32 v108, v108, v116, v165
    v_fma_f32 v109, v109, v117, v167
    v_cvt_pk_bf16_f32 v144, v104, v96
    v_cvt_pk_bf16_f32 v145, v105, v97
    v_cvt_pk_bf16_f32 v146, v106, v98
    v_cvt_pk_bf16_f32 v147, v107, v99
    v_mul_f32 v164, v102, v118
    v_mul_f32 v165, v102, v126
    v_mul_f32 v166, v103, v119
    v_mul_f32 v167, v103, v127
    v_fma_f32 v102, -v110, v126, v164
    v_fma_f32 v103, -v111, v127, v166
    v_fma_f32 v110, v110, v118, v165
    v_fma_f32 v111, v111, v119, v167
    v_mfma_f32_16x16x32_bf16 v[128:131], v[48:51], v[144:147], 0
    v_cvt_pk_bf16_f32 v148, v108, v100
    v_cvt_pk_bf16_f32 v149, v109, v101
    v_cvt_pk_bf16_f32 v150, v110, v102
    v_cvt_pk_bf16_f32 v151, v111, v103
    v_mfma_f32_16x16x32_bf16 v[136:139], v[64:67], v[144:147], 0
    s_nop 0
    v_mfma_f32_16x16x32_bf16 v[128:131], v[52:55], v[148:151], v[128:131]
    v_mfma_f32_16x16x32_bf16 v[136:139], v[68:71], v[148:151], v[136:139]
    v_mfma_f32_16x16x32_bf16 v[132:135], v[56:59], v[144:147], 0
    s_nop 5
    v_mul_f32 v160, v128, v80
    v_mfma_f32_16x16x32_bf16 v[140:143], v[72:75], v[144:147], 0
    v_mul_f32 v161, v128, v88
    v_fma_f32 v128, -v136, v88, v160
    v_mfma_f32_16x16x32_bf16 v[132:135], v[60:63], v[148:151], v[132:135]
    v_mul_f32 v162, v129, v81
    v_mul_f32 v163, v129, v89
    v_mfma_f32_16x16x32_bf16 v[140:143], v[76:79], v[148:151], v[140:143]
    v_fma_f32 v136, v136, v80, v161
    v_fma_f32 v129, -v137, v89, v162
    v_cvt_pk_bf16_f32 v144, v128, v136
    v_mul_f32 v160, v130, v82
    v_mul_f32 v161, v130, v90
    v_fma_f32 v137, v137, v81, v163
    ds_write_b32 v11, v144 offset:0
    v_fma_f32 v130, -v138, v90, v160
    v_cvt_pk_bf16_f32 v145, v129, v137
    v_mul_f32 v162, v131, v83
    v_mul_f32 v163, v131, v91
    v_fma_f32 v138, v138, v82, v161
    ds_write_b32 v11, v145 offset:288
    v_fma_f32 v131, -v139, v91, v162
    v_cvt_pk_bf16_f32 v146, v130, v138
    v_mul_f32 v164, v132, v84
    v_mul_f32 v165, v132, v92
    v_fma_f32 v139, v139, v83, v163
    ds_write_b32 v11, v146 offset:576
    v_fma_f32 v132, -v140, v92, v164
    v_cvt_pk_bf16_f32 v147, v131, v139
    v_mul_f32 v166, v133, v85
    v_mul_f32 v167, v133, v93
    v_fma_f32 v140, v140, v84, v165
    ds_write_b32 v11, v147 offset:864
    v_fma_f32 v133, -v141, v93, v166
    v_cvt_pk_bf16_f32 v148, v132, v140
    v_mul_f32 v164, v134, v86
    v_mul_f32 v165, v134, v94
    v_fma_f32 v141, v141, v85, v167
    ds_write_b32 v12, v148 offset:0
    v_fma_f32 v134, -v142, v94, v164
    v_cvt_pk_bf16_f32 v149, v133, v141
    v_mul_f32 v166, v135, v87
    v_mul_f32 v167, v135, v95
    v_fma_f32 v142, v142, v86, v165
    ds_write_b32 v12, v149 offset:288
    v_fma_f32 v135, -v143, v95, v166
    v_cvt_pk_bf16_f32 v150, v134, v142
    v_fma_f32 v143, v143, v87, v167
    ds_write_b32 v12, v150 offset:576
    v_cvt_pk_bf16_f32 v151, v135, v143
    ds_write_b32 v12, v151 offset:864
    s_waitcnt lgkmcnt(0)
    s_barrier
    ds_read_b128 v[96:99], v10 offset:9216
    ds_read_b128 v[112:115], v10 offset:13888
    ds_read_b128 v[100:103], v10 offset:9280
    ds_read_b128 v[116:119], v10 offset:13824
    ds_read_b128 v[104:107], v10 offset:9344
    ds_read_b128 v[120:123], v10 offset:14016
    ds_read_b128 v[108:111], v10 offset:9408
    ds_read_b128 v[124:127], v10 offset:13952
    s_waitcnt lgkmcnt(7)
    v_mfma_f32_16x16x32_bf16 v[128:131], v[96:99], v[16:19], 0
    v_mfma_f32_16x16x32_bf16 v[136:139], v[96:99], v[32:35], 0
    s_waitcnt lgkmcnt(6)
    v_mfma_f32_16x16x32_bf16 v[132:135], v[112:115], v[16:19], 0
    v_mfma_f32_16x16x32_bf16 v[140:143], v[112:115], v[32:35], 0
    s_waitcnt lgkmcnt(5)
    v_mfma_f32_16x16x32_bf16 v[128:131], v[100:103], v[20:23], v[128:131]
    v_mfma_f32_16x16x32_bf16 v[136:139], v[100:103], v[36:39], v[136:139]
    s_waitcnt lgkmcnt(4)
    v_mfma_f32_16x16x32_bf16 v[132:135], v[116:119], v[20:23], v[132:135]
    v_mfma_f32_16x16x32_bf16 v[140:143], v[116:119], v[36:39], v[140:143]
    s_waitcnt lgkmcnt(3)
    v_mfma_f32_16x16x32_bf16 v[128:131], v[104:107], v[24:27], v[128:131]
    v_mfma_f32_16x16x32_bf16 v[136:139], v[104:107], v[40:43], v[136:139]
    s_waitcnt lgkmcnt(2)
    v_mfma_f32_16x16x32_bf16 v[132:135], v[120:123], v[24:27], v[132:135]
    v_mfma_f32_16x16x32_bf16 v[140:143], v[120:123], v[40:43], v[140:143]
    s_waitcnt lgkmcnt(1)
    v_mfma_f32_16x16x32_bf16 v[128:131], v[108:111], v[28:31], v[128:131]
    v_mfma_f32_16x16x32_bf16 v[136:139], v[108:111], v[44:47], v[136:139]
    s_waitcnt lgkmcnt(0)
    v_mfma_f32_16x16x32_bf16 v[132:135], v[124:127], v[28:31], v[132:135]
    v_mfma_f32_16x16x32_bf16 v[140:143], v[124:127], v[44:47], v[140:143]
    s_nop 4
    v_cvt_pk_bf16_f32 v144, v136, v128
    v_cvt_pk_bf16_f32 v145, v137, v129
    v_cvt_pk_bf16_f32 v146, v138, v130
    v_cvt_pk_bf16_f32 v147, v139, v131
    v_mov_b32 v152, v144
    v_mov_b32 v153, v145
    v_mov_b32 v154, v146
    v_cvt_pk_bf16_f32 v148, v140, v132
    v_cvt_pk_bf16_f32 v149, v141, v133
    v_cvt_pk_bf16_f32 v150, v142, v134
    v_cvt_pk_bf16_f32 v151, v143, v135
    v_mov_b32 v155, v147
    v_mov_b32_dpp v144, v148 row_ror:8 row_mask:0xf bank_mask:0xc
    v_mov_b32_dpp v145, v149 row_ror:8 row_mask:0xf bank_mask:0xc
    v_mov_b32_dpp v146, v150 row_ror:8 row_mask:0xf bank_mask:0xc
    v_mov_b32_dpp v147, v151 row_ror:8 row_mask:0xf bank_mask:0xc
    buffer_store_dwordx4 v[144:147], v13, s[8:11], 0 offen offset:0 sc1
    v_mov_b32_dpp v148, v152 row_ror:8 row_mask:0xf bank_mask:0x3
    v_mov_b32_dpp v149, v153 row_ror:8 row_mask:0xf bank_mask:0x3
    v_mov_b32_dpp v150, v154 row_ror:8 row_mask:0xf bank_mask:0x3
    v_mov_b32_dpp v151, v155 row_ror:8 row_mask:0xf bank_mask:0x3
    buffer_store_dwordx4 v[148:151], v13, s[8:11], 0 offen offset:1024 sc1
    s_endpgm
.globl ssm_out_kernel
.p2align 8
.type ssm_out_kernel,@function
ssm_out_kernel:
    s_load_dwordx16 s[16:31], s[0:1], 0
    s_load_dwordx16 s[32:47], s[0:1], 64
    s_cmp_lt_u32 s2, 256
    s_cbranch_scc1 L_k3_go
    s_endpgm
L_k3_go:
    v_lshrrev_b32 v1, 6, v0
    v_and_b32 v2, 63, v0
    v_readfirstlane_b32 s3, v1
    s_and_b32 s4, s2, 7
    s_lshl_b32 s4, s4, 5
    s_lshr_b32 s5, s2, 3
    s_add_u32 s4, s4, s5
    s_lshl_b32 s4, s4, 3
    s_lshl_b32 s12, s4, 2
    s_add_u32 s12, s12, 0xb00000
    v_lshrrev_b32 v3, 1, v0
    v_mul_u32_u24 v3, 8448, v3
    v_and_b32 v4, 1, v0
    v_lshl_add_u32 v3, v4, 4, v3
    v_add_u32 v3, s12, v3
    s_lshl_b32 s13, s4, 1
    s_add_u32 s13, s13, 0xe00000
    v_mul_u32_u24 v5, 4352, v0
    v_add_u32 v5, s13, v5
    v_lshrrev_b32 v6, 5, v0
    v_bfe_u32 v7, v0, 1, 4
    v_mov_b32 v8, 0x7ffffff0
    v_mov_b32 v9, 16
    v_cmp_eq_u32 vcc, 0, v6
    s_nop 1
    v_cndmask_b32_e64 v9, v9, 9, vcc
    v_cmp_eq_u32 vcc, 14, v6
    s_nop 1
    v_cndmask_b32_e64 v9, v9, 8, vcc
    v_cmp_eq_u32 vcc, 15, v6
    s_nop 1
    v_cndmask_b32_e64 v9, v9, 0, vcc
    v_cmp_gt_u32 vcc, v9, v7
    s_nop 1
    v_cndmask_b32 v10, v8, v3, vcc
    v_cmp_gt_u32 vcc, 448, v0
    s_nop 1
    v_cndmask_b32 v12, v8, v5, vcc
    s_add_u32 s48, s4, s3
    s_lshl_b32 s50, s48, 2
    s_add_u32 s50, s50, 0x5f0000
    s_waitcnt lgkmcnt(0)
    s_mov_b32 s8, s46
    s_mov_b32 s9, s47
    s_mov_b32 s10, 0x1200000
    s_mov_b32 s11, 0x20000
    s_load_dword s60, s[46:47], s50
    buffer_load_dwordx4 v[16:19], v10, s[8:11], 0 offen
    s_mov_b32 s56, s42
    s_mov_b32 s57, s43
    s_mov_b32 s58, 0x1c0000
    s_mov_b32 s59, 0x20000
    v_mul_u32_u24 v9, 4160, v4
    v_lshrrev_b32 v13, 2, v6
    v_and_b32 v13, 1, v13
    v_lshlrev_b32 v13, 3, v13
    v_xor_b32 v13, v13, v7
    v_lshl_add_u32 v13, v6, 4, v13
    v_lshl_add_u32 v13, v13, 2, v9
    v_lshrrev_b32 v14, 4, v0
    v_add_u32 v14, v14, v0
    v_lshlrev_b32 v14, 4, v14
    v_add_u32 v14, 8320, v14
    v_and_b32 v15, 15, v2
    v_lshrrev_b32 v32, 4, v2
    v_lshrrev_b32 v33, 2, v15
    v_and_b32 v33, 1, v33
    v_lshlrev_b32 v33, 1, v33
    v_xor_b32 v33, v33, v32
    v_lshlrev_b32 v33, 4, v33
    v_lshl_add_u32 v33, v15, 6, v33
    s_mul_i32 s54, s3, 1040
    v_add_u32 v33, s54, v33
    v_mul_u32_u24 v34, 272, v15
    v_lshl_add_u32 v34, v32, 6, v34
    s_lshl_b32 s54, s3, 1
    s_add_u32 s54, s54, 8320
    v_add_u32 v34, s54, v34
    v_lshrrev_b32 v35, 1, v32
    v_lshlrev_b32 v35, 4, v35
    v_lshl_add_u32 v35, v15, 5, v35
    v_and_b32 v36, 1, v32
    v_lshl_add_u32 v35, v36, 9, v35
    s_mul_i32 s54, s48, 896
    v_add_u32 v35, s54, v35
    v_cvt_f32_u32 v64, v15
    v_lshlrev_b32 v65, 2, v32
    v_cvt_f32_u32 v65, v65
    v_mul_f32 v63, 0x3d800000, v64
    v_mul_f32 v66, v65, v63
    v_mov_b32 v60, v66
    v_cos_f32 v61, v60
    v_sin_f32 v62, v60
    s_nop 0
    v_cvt_pk_bf16_f32 v36, v61, -v62
    v_cvt_pk_bf16_f32 v40, v62, v61
    v_fmamk_f32 v60, v63, 0x3f800000, v66
    v_cos_f32 v61, v60
    v_sin_f32 v62, v60
    s_nop 0
    v_cvt_pk_bf16_f32 v37, v61, -v62
    v_cvt_pk_bf16_f32 v41, v62, v61
    v_fmamk_f32 v60, v63, 0x40000000, v66
    v_cos_f32 v61, v60
    v_sin_f32 v62, v60
    s_nop 0
    v_cvt_pk_bf16_f32 v38, v61, -v62
    v_cvt_pk_bf16_f32 v42, v62, v61
    v_fmamk_f32 v60, v63, 0x40400000, v66
    v_cos_f32 v61, v60
    v_sin_f32 v62, v60
    s_nop 0
    v_cvt_pk_bf16_f32 v39, v61, -v62
    v_cvt_pk_bf16_f32 v43, v62, v61
    buffer_load_dwordx4 v[24:27], v12, s[8:11], 0 offen
    v_mul_f32 v63, 0x3b124925, v64
    v_mul_f32 v66, v65, v63
    v_mov_b32 v60, v66
    v_cos_f32 v44, v60
    v_sin_f32 v48, v60
    v_fmamk_f32 v60, v63, 0x3f800000, v66
    v_cos_f32 v45, v60
    v_sin_f32 v49, v60
    v_fmamk_f32 v60, v63, 0x40000000, v66
    v_cos_f32 v46, v60
    v_sin_f32 v50, v60
    v_fmamk_f32 v60, v63, 0x40400000, v66
    v_cos_f32 v47, v60
    v_sin_f32 v51, v60
    v_add_f32 v63, 0, v64
    v_mul_f32 v63, 0x3d124925, v63
    v_mul_f32 v66, v65, v63
    v_mov_b32 v60, v66
    v_cos_f32 v61, v60
    v_sin_f32 v62, v60
    s_nop 0
    v_cvt_pk_bf16_f32 v52, v61, -v62
    v_fmamk_f32 v60, v63, 0x3f800000, v66
    v_cos_f32 v61, v60
    v_sin_f32 v62, v60
    s_nop 0
    v_cvt_pk_bf16_f32 v53, v61, -v62
    v_fmamk_f32 v60, v63, 0x40000000, v66
    v_cos_f32 v61, v60
    v_sin_f32 v62, v60
    s_nop 0
    v_cvt_pk_bf16_f32 v54, v61, -v62
    v_fmamk_f32 v60, v63, 0x40400000, v66
    v_cos_f32 v61, v60
    v_sin_f32 v62, v60
    s_nop 0
    v_cvt_pk_bf16_f32 v55, v61, -v62
    v_add_f32 v63, 0x41800000, v64
    v_mul_f32 v63, 0x3d124925, v63
    v_mul_f32 v66, v65, v63
    v_mov_b32 v60, v66
    v_cos_f32 v61, v60
    v_sin_f32 v62, v60
    s_nop 0
    v_cvt_pk_bf16_f32 v56, v61, -v62
    v_fmamk_f32 v60, v63, 0x3f800000, v66
    v_cos_f32 v61, v60
    v_sin_f32 v62, v60
    s_nop 0
    v_cvt_pk_bf16_f32 v57, v61, -v62
    v_fmamk_f32 v60, v63, 0x40000000, v66
    v_cos_f32 v61, v60
    v_sin_f32 v62, v60
    s_nop 0
    v_cvt_pk_bf16_f32 v58, v61, -v62
    v_fmamk_f32 v60, v63, 0x40400000, v66
    v_cos_f32 v61, v60
    v_sin_f32 v62, v60
    s_nop 0
    v_cvt_pk_bf16_f32 v59, v61, -v62
    v_cmp_gt_u32 vcc, 3, v32
    s_nop 1
    v_cndmask_b32 v55, 0, v55, vcc
    v_cndmask_b32 v59, 0, v59, vcc
    s_waitcnt vmcnt(1) lgkmcnt(0)
    s_mov_b32 s64, s60
    s_mov_b32 s65, s60
    ds_write_b32 v13, v16 offset:0
    ds_write_b32 v13, v17 offset:1040
    ds_write_b32 v13, v18 offset:2080
    ds_write_b32 v13, v19 offset:3120
    s_waitcnt lgkmcnt(0)
    s_barrier
    ds_read_b128 v[16:19], v33
    s_waitcnt lgkmcnt(0)
    v_mfma_f32_16x16x32_bf16 v[76:79], v[16:19], v[36:39], 0
    v_mfma_f32_16x16x32_bf16 v[80:83], v[16:19], v[40:43], 0
    s_nop 6
    v_pk_mul_f32 v[60:61], v[76:77], v[44:45]
    v_pk_mul_f32 v[62:63], v[76:77], v[48:49]
    v_pk_fma_f32 v[76:77], v[80:81], v[48:49], v[60:61] neg_lo:[0,1,0] neg_hi:[0,1,0]
    v_pk_fma_f32 v[80:81], v[80:81], v[44:45], v[62:63]
    v_pk_mul_f32 v[60:61], v[78:79], v[46:47]
    v_pk_mul_f32 v[62:63], v[78:79], v[50:51]
    v_pk_fma_f32 v[78:79], v[82:83], v[50:51], v[60:61] neg_lo:[0,1,0] neg_hi:[0,1,0]
    v_pk_fma_f32 v[82:83], v[82:83], v[46:47], v[62:63]
    v_cvt_pk_bf16_f32 v16, v76, v80
    v_cvt_pk_bf16_f32 v17, v77, v81
    v_cvt_pk_bf16_f32 v18, v78, v82
    v_cvt_pk_bf16_f32 v19, v79, v83
    s_nop 1
    v_mfma_f32_16x16x32_bf16 v[76:79], v[16:19], v[52:55], 0
    v_mfma_f32_16x16x32_bf16 v[80:83], v[16:19], v[56:59], 0
    s_waitcnt vmcnt(0)
    s_cmp_lt_u32 s3, 7
    s_cbranch_scc0 L_k3_noa
    ds_write_b128 v14, v[24:27]
L_k3_noa:
    s_waitcnt lgkmcnt(0)
    s_barrier
    ds_read_u16 v68, v34 offset:0
    ds_read_u16 v69, v34 offset:16
    ds_read_u16 v70, v34 offset:32
    ds_read_u16 v71, v34 offset:48
    ds_read_u16 v72, v34 offset:4352
    ds_read_u16 v73, v34 offset:4368
    ds_read_u16 v74, v34 offset:4384
    ds_read_u16 v75, v34 offset:4400
    s_waitcnt lgkmcnt(7)
    v_lshlrev_b32 v68, 16, v68
    s_waitcnt lgkmcnt(6)
    v_lshlrev_b32 v69, 16, v69
    v_pk_add_f32 v[68:69], v[68:69], v[76:77] neg_lo:[0,1] neg_hi:[0,1]
    s_waitcnt lgkmcnt(5)
    v_lshlrev_b32 v70, 16, v70
    v_pk_fma_f32 v[68:69], v[68:69], s[64:65], v[76:77]
    s_waitcnt lgkmcnt(4)
    v_lshlrev_b32 v71, 16, v71
    s_waitcnt lgkmcnt(3)
    v_lshlrev_b32 v72, 16, v72
    v_pk_add_f32 v[70:71], v[70:71], v[78:79] neg_lo:[0,1] neg_hi:[0,1]
    s_waitcnt lgkmcnt(2)
    v_lshlrev_b32 v73, 16, v73
    v_pk_add_f32 v[72:73], v[72:73], v[80:81] neg_lo:[0,1] neg_hi:[0,1]
    s_waitcnt lgkmcnt(1)
    v_lshlrev_b32 v74, 16, v74
    s_waitcnt lgkmcnt(0)
    v_lshlrev_b32 v75, 16, v75
    v_pk_add_f32 v[74:75], v[74:75], v[82:83] neg_lo:[0,1] neg_hi:[0,1]
    v_pk_fma_f32 v[70:71], v[70:71], s[64:65], v[78:79]
    v_pk_fma_f32 v[72:73], v[72:73], s[64:65], v[80:81]
    v_pk_fma_f32 v[74:75], v[74:75], s[64:65], v[82:83]
    v_cvt_pk_bf16_f32 v4, v68, v69
    v_cvt_pk_bf16_f32 v5, v70, v71
    v_cvt_pk_bf16_f32 v6, v72, v73
    v_cvt_pk_bf16_f32 v7, v74, v75
    s_nop 0
    v_permlane16_swap_b32 v4, v6
    v_permlane16_swap_b32 v5, v7
    s_mov_b32 exec_lo, 0x0fffffff
    s_mov_b32 exec_hi, 0x0fffffff
    buffer_store_dwordx4 v[4:7], v35, s[56:59], 0 offen sc1
    s_endpgm
code_end:
.section .rodata,"a"
.p2align 6
.amdhsa_kernel ssm_prep_kernel
  .amdhsa_next_free_vgpr 128
  .amdhsa_next_free_sgpr 96
  .amdhsa_accum_offset 128
  .amdhsa_group_segment_fixed_size 0
  .amdhsa_kernarg_size 128
  .amdhsa_user_sgpr_count 2
  .amdhsa_user_sgpr_kernarg_segment_ptr 1
  .amdhsa_system_sgpr_workgroup_id_x 1
  .amdhsa_float_denorm_mode_32 3
.end_amdhsa_kernel
.p2align 6
.amdhsa_kernel ssm_mix_kernel
  .amdhsa_next_free_vgpr 168
  .amdhsa_next_free_sgpr 96
  .amdhsa_accum_offset 168
  .amdhsa_group_segment_fixed_size 0
  .amdhsa_kernarg_size 128
  .amdhsa_user_sgpr_count 2
  .amdhsa_user_sgpr_kernarg_segment_ptr 1
  .amdhsa_system_sgpr_workgroup_id_x 1
  .amdhsa_float_denorm_mode_32 3
.end_amdhsa_kernel
.p2align 6
.amdhsa_kernel ssm_out_kernel
  .amdhsa_next_free_vgpr 88
  .amdhsa_next_free_sgpr 96
  .amdhsa_accum_offset 88
  .amdhsa_group_segment_fixed_size 0
  .amdhsa_kernarg_size 128
  .amdhsa_user_sgpr_count 2
  .amdhsa_user_sgpr_kernarg_segment_ptr 1
  .amdhsa_system_sgpr_workgroup_id_x 1
  .amdhsa_float_denorm_mode_32 3
.end_amdhsa_kernel
```
